```python
import torch

def _softmax(x, axis=-1):
    return torch.softmax(x, dim=axis)
def _gelu(x):
    return torch.nn.functional.gelu(x, approximate="tanh")
def _silu(x):
    return torch.nn.functional.silu(x)
def _sigmoid(x):
    return torch.sigmoid(x)
def _layernorm(x, axis=-1, eps=1e-5):
    m = x.mean(dim=axis, keepdim=True)
    v = x.var(dim=axis, keepdim=True, unbiased=False)
    return (x - m) / torch.sqrt(v + eps)
def _scatter_add(tgt, idx, src, axis=0):
    return tgt.clone().index_add_(axis, idx, src)
def _segment_sum(src, seg, n):
    out = torch.zeros((n,) + src.shape[1:], dtype=src.dtype)
    return out.index_add_(0, seg, src)
def _pad(x, pw):
    flat = tuple(v for pair in reversed(pw) for v in pair)
    return torch.nn.functional.pad(x, flat)

kernel_name = 'interleave_layers__sliding_block_cached__mixer_token_mlp__decode'

def setup_inputs():

    _w = (lambda a: (lambda t: t.to(torch.bfloat16) if t.is_floating_point() else t)(torch.as_tensor(a)))
    def _A_setup():
        B, Sq, D = 2, 1, 576
        Hq, Hkv, Sk, Dh = 32, 16, 8192, 128
        assert Hq % Hkv == 0, (Hq, Hkv)
        return {
            "x": _w((lambda *s: torch.randn(*s, dtype=torch.bfloat16) * 0.1)(B, Sq, D)),
            "k_cache": _w((lambda *s: torch.randn(*s, dtype=torch.bfloat16) * 0.8)(B, Hkv, Sk, Dh)),
            "v_cache": _w((lambda *s: torch.randn(*s, dtype=torch.bfloat16) * 3.2)(B, Hkv, Sk, Dh)),
            "wq": _w((lambda *s: torch.randn(*s, dtype=torch.bfloat16) * 0.8)(D, Hq * Dh) * (D ** -0.5)),
            "wo": _w((lambda *s: torch.randn(*s, dtype=torch.bfloat16) * 3.2)(Hq * Dh, D) * ((Hq * Dh) ** -0.5)),
        }
    _A_in = _A_setup()

    def _B_setup():
        B, S, D, F = 2, 1, 576, 4608
        return {
            "x": _w((lambda *s: torch.randn(*s, dtype=torch.bfloat16) * 0.1)(B, S, D)),
            "w1": _w((lambda *s: torch.randn(*s, dtype=torch.bfloat16) * 3.2)(S, F) * (S ** -0.5)),
            "b1": _w((lambda *s: torch.randn(*s, dtype=torch.bfloat16) * 3.2)(F) * 0.02),
            "w2": _w((lambda *s: torch.randn(*s, dtype=torch.bfloat16) * 0.8)(F, S) * (F ** -0.5)),
            "b2": _w((lambda *s: torch.randn(*s, dtype=torch.bfloat16) * 0.8)(S) * 0.02),
        }
    _B_in = _B_setup()

    return {
        "A_x": _A_in["x"],
        "A_k_cache": _A_in["k_cache"],
        "A_v_cache": _A_in["v_cache"],
        "A_wq": _A_in["wq"],
        "A_wo": _A_in["wo"],
        "B_x": _B_in["x"],
        "B_w1": _B_in["w1"],
        "B_b1": _B_in["b1"],
        "B_w2": _B_in["w2"],
        "B_b2": _B_in["b2"],
    }

def reference(A_x, A_k_cache, A_v_cache, A_wq, A_wo, B_x, B_w1, B_b1, B_w2, B_b2):
    def _A_ref(x, k_cache, v_cache, wq, wo):
        B, Sq, D = x.shape
        Hq, Dh = 32, 128
        Hkv, Sk = k_cache.shape[1], k_cache.shape[2]
        W = min(4096, max(256, Sk // 4))
        rep = Hq // Hkv
        q = (lambda x, *d: x.permute(*d))((x @ wq).reshape(B, Sq, Hq, Dh), 0, 2, 1, 3)
        k = (lambda x, n, axis: torch.repeat_interleave(x, n, dim=axis))(k_cache[:, :, Sk - W:, :], rep, axis=1)
        v = (lambda x, n, axis: torch.repeat_interleave(x, n, dim=axis))(v_cache[:, :, Sk - W:, :], rep, axis=1)
        scores = torch.einsum("bhqd,bhkd->bhqk", q, k) * (Dh ** -0.5)
        p = _softmax(scores, axis=-1)
        o = torch.einsum("bhqk,bhkd->bhqd", p, v)
        return (lambda x, *d: x.permute(*d))(o, 0, 2, 1, 3).reshape(B, Sq, Hq * Dh) @ wo

    def _B_ref(x, w1, b1, w2, b2):
        B, S, D = x.shape
        h = _layernorm(x, axis=-1)
        u = torch.einsum("bsd,sf->bdf", h, w1) + b1
        u = _gelu(u)
        y = torch.einsum("bdf,fs->bds", u, w2) + b2
        return (lambda x, *d: x.permute(*d))(y, 0, 2, 1)

    x = A_x
    x = x + _A_ref(_layernorm(x, axis=-1), A_k_cache, A_v_cache, A_wq, A_wo)
    x = x + _B_ref(_layernorm(x, axis=-1), B_w1, B_b1, B_w2, B_b2)
    x = x + _A_ref(_layernorm(x, axis=-1), A_k_cache, A_v_cache, A_wq, A_wo)
    x = x + _B_ref(_layernorm(x, axis=-1), B_w1, B_b1, B_w2, B_b2)
    return x
```

```asm
; @launch grid=(256,1,1) block=(512,1,1) lds=163840
.amdgcn_target "amdgcn-amd-amdhsa--gfx950"
.text
.globl interleave_layers__sliding_block_cached__mixer_token_mlp__decode_kernel
.p2align 8
.type interleave_layers__sliding_block_cached__mixer_token_mlp__decode_kernel,@function
interleave_layers__sliding_block_cached__mixer_token_mlp__decode_kernel:
    s_load_dwordx16 s[56:71], s[0:1], 0
    s_load_dwordx4 s[72:75], s[0:1], 64
    s_load_dwordx2 s[42:43], s[0:1], 96
    s_lshr_b32 s4, s2, 8
    s_cbranch_scc1 L_end
    v_lshrrev_b32 v82, 6, v0
    v_lshrrev_b32 v86, 5, v0
    s_and_b32 s44, s2, 7
    v_readfirstlane_b32 s3, v82
    s_bfe_u32 s46, s2, 0x10006
    s_bfe_u32 s47, s2, 0x30003
    s_lshl1_add_u32 s48, s44, s46
    s_cmp_lt_u32 s3, 4
    s_cbranch_scc1 L_centry
    v_bfe_u32 v87, v0, 4, 4
    v_and_b32 v86, 4, v86
    v_and_or_b32 v86, v87, 3, v86
    v_lshlrev_b32 v86, 1, v86
    v_xor_b32 v86, v86, v0
    v_and_b32 v86, 15, v86
    v_lshlrev_b32 v86, 4, v86
    v_lshl_add_u32 v90, v87, 13, v86
    s_lshr_b32 s4, s47, 1
    s_mul_i32 s6, s4, 1179648
    s_and_b32 s5, s47, 1
    s_lshl1_add_u32 s5, s48, s5
    s_lshl_b32 s5, s5, 8
    s_add_u32 s6, s6, s5
    s_sub_u32 s18, 4718592, s6
    s_mov_b32 s19, 0x20000
    s_lshl_b32 s81, s3, 10
    s_add_u32 m0, s81, 114688
    s_mov_b32 s7, 0
    s_waitcnt lgkmcnt(0)
    s_add_u32 s16, s62, s6
    s_addc_u32 s17, s63, 0
L_wql:
    buffer_load_dwordx4 v90, s[16:19], s7 offen nt lds
    s_add_u32 m0, m0, 4096
    s_add_u32 s7, s7, 131072
    s_cmp_lt_u32 s7, 1179648
    s_cbranch_scc1 L_wql
    v_and_b32 v83, 63, v0
    v_lshlrev_b32 v2, 2, v0
    v_lshlrev_b32 v1, 2, v83
    v_and_b32 v84, 15, v83
    v_lshrrev_b32 v85, 4, v83
    s_lshr_b32 s45, s2, 7
    s_bfe_u32 s49, s2, 0x40003
    v_xor_b32 v80, v87, v84
    v_lshlrev_b32 v80, 4, v80
    v_lshl_add_u32 v80, v85, 8, v80
    s_lshl4_add_u32 s5, s45, s48
    s_lshl_b32 s5, s5, 5
    s_add_u32 s5, s5, s47
    s_add_u32 s5, s5, 24
    s_lshl_b32 s5, s5, 16
    s_mov_b32 s11, s19
    s_mov_b32 s10, 0x10000
    s_and_b32 s81, s81, 0xc00
    s_mul_i32 s80, s2, 0x9e3779b1
    s_lshr_b32 s80, s80, 28
    s_lshl_b32 s80, s80, 12
    s_add_u32 s80, s80, s81
    s_add_u32 s8, s58, s5
    s_addc_u32 s9, s59, 0
    v_add_u32 v100, 4096, v2
    v_lshlrev_b32 v101, 1, v0
    v_add_u32 v101, 8192, v101
    global_load_dword v102, v2, s[68:69] offset:0
    global_load_dword v103, v2, s[68:69] offset:2048
    global_load_dword v104, v100, s[68:69] offset:0
    global_load_dword v105, v100, s[68:69] offset:2048
    global_load_ushort v106, v101, s[68:69]
    global_load_dword v107, v2, s[70:71] offset:0
    global_load_dword v108, v2, s[70:71] offset:2048
    global_load_dword v109, v100, s[70:71] offset:0
    global_load_dword v110, v100, s[70:71] offset:2048
    global_load_ushort v111, v101, s[70:71]
    global_load_dword v112, v2, s[72:73] offset:0
    global_load_dword v113, v2, s[72:73] offset:2048
    global_load_dword v114, v100, s[72:73] offset:0
    global_load_dword v115, v100, s[72:73] offset:2048
    global_load_ushort v116, v101, s[72:73]
    s_add_u32 m0, s81, 0
    s_and_b32 s80, s80, 65535
    buffer_load_dwordx4 v80, s[8:11], s80 offen nt lds
    s_add_u32 s80, s80, 4096
    s_add_u32 m0, s81, 4096
    s_and_b32 s80, s80, 65535
    buffer_load_dwordx4 v80, s[8:11], s80 offen nt lds
    s_add_u32 s80, s80, 4096
    s_add_u32 m0, s81, 8192
    s_and_b32 s80, s80, 65535
    buffer_load_dwordx4 v80, s[8:11], s80 offen nt lds
    s_add_u32 s80, s80, 4096
    s_add_u32 m0, s81, 12288
    s_and_b32 s80, s80, 65535
    buffer_load_dwordx4 v80, s[8:11], s80 offen nt lds
    s_add_u32 s80, s80, 4096
    s_add_u32 m0, s81, 16384
    s_and_b32 s80, s80, 65535
    buffer_load_dwordx4 v80, s[8:11], s80 offen nt lds
    s_add_u32 s80, s80, 4096
    s_add_u32 s12, s60, s5
    s_addc_u32 s13, s61, 0
    s_mov_b32 s14, s10
    s_mov_b32 s15, s11
    v_lshl_add_u32 v81, v85, 8, v86
    s_add_u32 m0, s81, 20480
    s_and_b32 s80, s80, 65535
    buffer_load_dwordx4 v80, s[8:11], s80 offen nt lds
    s_add_u32 s80, s80, 4096
    s_waitcnt vmcnt(21)
    s_barrier
    s_add_u32 m0, s81, 24576
    s_and_b32 s80, s80, 65535
    buffer_load_dwordx4 v80, s[8:11], s80 offen nt lds
    s_add_u32 s80, s80, 4096
    s_lshr_b32 s4, s47, 1
    s_lshl_b32 s5, s45, 4
    s_add_u32 s5, s5, s48
    s_and_b32 s7, s3, 3
    s_lshl_b32 s6, s7, 2
    s_add_u32 s6, s6, 163456
    v_mov_b32 v7, s6
    s_mov_b64 s[30:31], s[68:69]
    s_mov_b64 s[32:33], s[70:71]
    s_mov_b64 s[34:35], s[72:73]
    s_mov_b64 s[36:37], s[74:75]
    s_mul_i32 s6, s44, 589824
    s_add_u32 s20, s64, s6
    s_addc_u32 s21, s65, 0
    s_sub_u32 s22, 4718592, s6
    s_mov_b32 s23, 0x20000
    s_mov_b32 s24, s42
    s_mov_b32 s25, s43
    s_mov_b32 s26, 2097152
    s_mov_b32 s27, 0x20000
    s_load_dword s67, s[36:37], 0
    s_getreg_b32 s75, hwreg(HW_REG_XCC_ID, 0, 4)
    s_mov_b32 s53, 0
    s_mov_b32 s54, 0
    s_mov_b32 s55, 4194304
    s_mov_b32 s39, 0
    s_mov_b32 s74, 155648
    s_lshl_b32 s57, s5, 12
    s_lshl_b32 s6, s4, 10
    s_add_u32 s56, s57, s6
    s_and_b32 s6, s47, 1
    s_lshl_b32 s6, s6, 9
    s_add_u32 s56, s56, s6
    s_lshl_b32 s6, s7, 7
    s_add_u32 s56, s56, s6
    s_mov_b32 s68, 0
    s_mov_b32 s69, -1
    s_mov_b32 s38, 0x07060302
    s_lshl_b32 s6, s3, 3
    s_add_u32 s6, s6, 161280
    v_lshrrev_b32 v86, 1, v85
    v_lshl_add_u32 v86, v86, 2, s6
    v_mov_b32 v87, 161344
    v_and_b32 v88, 1, v85
    v_cmp_eq_u32 vcc, 1, v88
    s_nop 1
    v_cndmask_b32 v9, v87, v86, vcc
    s_lshl_b32 s50, s44, 4
    s_add_u32 s50, s50, s49
    s_mul_i32 s6, s50, 5
    s_lshl_b32 s76, s50, 2
    s_add_u32 s76, s76, 64
    s_cmp_lt_u32 s50, 64
    s_cselect_b32 s51, s6, s76
    s_cselect_b32 s52, 5, 4
    s_lshl_b32 s5, s45, 3
    s_add_u32 s5, s5, s44
    s_lshl_b32 s6, s5, 13
    s_add_u32 s6, s6, 1048576
    s_lshl_b32 s60, s7, 11
    s_add_u32 s60, s60, s6
    s_lshl_b32 s58, s49, 8
    s_add_u32 s6, s6, s58
    s_lshl_b32 s58, s46, 11
    s_add_u32 s6, s6, s58
    s_lshl_b32 s58, s7, 6
    s_add_u32 s58, s58, s6
    s_lshl_b32 s6, s5, 7
    s_add_u32 s6, s6, 1441792
    s_lshl_b32 s61, s7, 5
    s_add_u32 s61, s61, s6
    s_lshl_b32 s59, s46, 6
    s_add_u32 s6, s6, s59
    s_lshl_b32 s59, s47, 2
    s_add_u32 s59, s59, s6
    s_mul_i32 s63, s5, 16384
    s_add_u32 s63, s63, 1179648
    s_add_u32 s64, s63, 4096
    s_and_b32 s6, s49, 7
    s_lshl_b32 s6, s6, 5
    s_lshr_b32 s76, s49, 3
    s_lshl_b32 s76, s76, 9
    s_add_u32 s6, s6, s76
    s_lshl_b32 s76, s7, 8
    s_add_u32 s6, s6, s76
    s_add_u32 s6, s6, 512
    s_lshl_b32 s76, s49, 6
    s_lshl_b32 s62, s7, 5
    s_add_u32 s76, s76, s62
    s_bitcmp1_b32 s7, 1
    s_cselect_b32 s6, s6, s76
    s_mul_i32 s76, s45, 131072
    s_add_u32 s6, s6, s76
    s_mul_i32 s62, s44, 2048
    s_add_u32 s6, s6, s62
    s_add_u32 s62, s6, 1179648
    s_mul_i32 s65, s5, 2560
    s_add_u32 s65, s65, 1843200
    s_mul_i32 s6, s45, 20480
    s_lshl_b32 s66, s51, 2
    s_add_u32 s66, s66, s6
    s_add_u32 s66, s66, 1843200
    s_mov_b32 s70, 0x10f
    s_mov_b32 s71, 0x10f0
    s_mov_b32 s72, 0x70c00
    s_mov_b32 s73, 0x70c000
    v_bfe_u32 v86, v83, 3, 2
    v_and_b32 v87, 3, v83
    v_lshl_add_u32 v86, v86, 2, v87
    v_subrev_u32 v87, 6, v86
    v_min_u32 v86, v86, v87
    v_min_u32 v86, 4, v86
    s_lshl_b32 s6, s51, 2
    s_add_u32 s6, s6, 155648
    v_lshl_add_u32 v8, v86, 2, s6
    v_lshrrev_b32 v89, 1, v85
    v_lshl_add_u32 v89, v89, 4, v84
    v_lshlrev_b32 v89, 1, v89
    v_lshlrev_b32 v6, 5, v88
    v_add_u32 v6, 161216, v6
    s_and_b32 s4, s3, 3
    s_lshr_b32 s5, s47, 1
    s_lshl_b32 s6, s5, 5
    s_add_u32 s6, s6, 162880
    s_mul_i32 s5, s5, 288
    s_add_u32 s5, s5, 158976
    v_bfe_u32 v88, v1, 2, 4
    v_mov_b32 v3, s6
    v_mov_b32 v86, s5
    v_cmp_eq_u32 vcc, 0, v88
    v_add_u32 v87, 2432, v86
    v_lshrrev_b32 v89, 6, v1
    v_cndmask_b32 v3, v3, v86, vcc
    v_cmp_eq_u32 vcc, 1, v88
    s_nop 1
    v_cndmask_b32 v3, v3, v87, vcc
    v_lshl_add_u32 v3, v89, 4, v3
    v_lshlrev_b32 v4, 4, v85
    v_add_u32 v4, 155648, v4
    v_and_b32 v86, 1, v84
    v_lshl_add_u32 v86, v85, 1, v86
    v_mul_u32_u24 v86, 16384, v86
    v_lshrrev_b32 v87, 1, v84
    v_lshl_add_u32 v5, v87, 2, v86
    s_waitcnt vmcnt(6)
    s_add_u32 m0, s81, 28672
    s_and_b32 s80, s80, 65535
    buffer_load_dwordx4 v80, s[8:11], s80 offen nt lds
    s_add_u32 s80, s80, 4096
    s_and_b32 s5, s3, 3
    s_lshl_b32 s5, s5, 1
    s_add_u32 s5, s5, 0
    v_bfe_u32 v90, v1, 4, 2
    v_bfe_u32 v91, v1, 2, 2
    v_lshrrev_b32 v92, 6, v1
    v_bfe_u32 v93, v92, 0, 1
    v_lshl_or_b32 v93, v93, 2, v90
    v_xor_b32 v93, s5, v93
    v_lshlrev_b32 v93, 5, v93
    v_lshl_add_u32 v93, v91, 3, v93
    v_lshl_add_u32 v92, v92, 3, v90
    v_lshl_add_u32 v94, v92, 8, v93
    v_add_u32 v94, 118784, v94
    v_bfe_u32 v90, v1, 4, 2
    v_bfe_u32 v91, v1, 2, 2
    v_lshrrev_b32 v92, 6, v1
    v_bfe_u32 v93, v92, 1, 1
    v_lshl_or_b32 v93, v93, 2, v90
    v_xor_b32 v93, s5, v93
    v_lshlrev_b32 v93, 5, v93
    v_lshl_add_u32 v93, v91, 3, v93
    v_lshl_add_u32 v92, v92, 2, v90
    v_lshl_add_u32 v95, v92, 8, v93
    v_add_u32 v95, 151552, v95
    s_and_b32 s5, s3, 3
    s_lshl_b32 s5, s5, 1
    s_add_u32 s5, s5, 1
    v_bfe_u32 v90, v1, 4, 2
    v_bfe_u32 v91, v1, 2, 2
    v_lshrrev_b32 v92, 6, v1
    v_bfe_u32 v93, v92, 0, 1
    v_lshl_or_b32 v93, v93, 2, v90
    v_xor_b32 v93, s5, v93
    v_lshlrev_b32 v93, 5, v93
    v_lshl_add_u32 v93, v91, 3, v93
    v_lshl_add_u32 v92, v92, 3, v90
    v_lshl_add_u32 v96, v92, 8, v93
    v_add_u32 v96, 118784, v96
    v_bfe_u32 v90, v1, 4, 2
    v_bfe_u32 v91, v1, 2, 2
    v_lshrrev_b32 v92, 6, v1
    v_bfe_u32 v93, v92, 1, 1
    v_lshl_or_b32 v93, v93, 2, v90
    v_xor_b32 v93, s5, v93
    v_lshlrev_b32 v93, 5, v93
    v_lshl_add_u32 v93, v91, 3, v93
    v_lshl_add_u32 v92, v92, 2, v90
    v_lshl_add_u32 v97, v92, 8, v93
    v_add_u32 v97, 151552, v97
    s_waitcnt vmcnt(6)
    s_add_u32 m0, s81, 32768
    s_and_b32 s80, s80, 65535
    buffer_load_dwordx4 v80, s[8:11], s80 offen nt lds
    s_add_u32 s80, s80, 4096
    s_waitcnt vmcnt(6)
    s_add_u32 m0, s81, 36864
    s_and_b32 s80, s80, 65535
    buffer_load_dwordx4 v80, s[8:11], s80 offen nt lds
    s_add_u32 s80, s80, 4096
    s_waitcnt vmcnt(6)
    s_add_u32 m0, s81, 40960
    s_and_b32 s80, s80, 65535
    buffer_load_dwordx4 v80, s[8:11], s80 offen nt lds
    s_add_u32 s80, s80, 4096
    s_waitcnt vmcnt(6)
    s_add_u32 m0, s81, 45056
    s_and_b32 s80, s80, 65535
    buffer_load_dwordx4 v80, s[8:11], s80 offen nt lds
    s_add_u32 s80, s80, 4096
    s_waitcnt vmcnt(6)
    s_add_u32 m0, s81, 49152
    s_and_b32 s80, s80, 65535
    buffer_load_dwordx4 v80, s[8:11], s80 offen nt lds
    s_add_u32 s80, s80, 4096
    s_waitcnt vmcnt(6)
    s_add_u32 m0, s81, 53248
    s_and_b32 s80, s80, 65535
    buffer_load_dwordx4 v80, s[8:11], s80 offen nt lds
    s_add_u32 s80, s80, 4096
    s_waitcnt vmcnt(6)
    ds_read_b64_tr_b16 a[64:65], v94 offset:0
    ds_read_b64_tr_b16 a[66:67], v94 offset:1024
    ds_read_b64_tr_b16 a[68:69], v94 offset:8192
    ds_read_b64_tr_b16 a[70:71], v94 offset:9216
    ds_read_b64_tr_b16 a[72:73], v94 offset:16384
    ds_read_b64_tr_b16 a[74:75], v94 offset:17408
    ds_read_b64_tr_b16 a[76:77], v94 offset:24576
    ds_read_b64_tr_b16 a[78:79], v94 offset:25600
    ds_read_b64_tr_b16 a[96:97], v95
    ds_read_b64_tr_b16 a[80:81], v96 offset:0
    ds_read_b64_tr_b16 a[82:83], v96 offset:1024
    ds_read_b64_tr_b16 a[84:85], v96 offset:8192
    ds_read_b64_tr_b16 a[86:87], v96 offset:9216
    ds_read_b64_tr_b16 a[88:89], v96 offset:16384
    ds_read_b64_tr_b16 a[90:91], v96 offset:17408
    ds_read_b64_tr_b16 a[92:93], v96 offset:24576
    ds_read_b64_tr_b16 a[94:95], v96 offset:25600
    ds_read_b64_tr_b16 a[98:99], v97
    s_add_u32 m0, s81, 57344
    s_and_b32 s80, s80, 65535
    buffer_load_dwordx4 v80, s[8:11], s80 offen nt lds
    s_add_u32 s80, s80, 4096
    s_waitcnt vmcnt(6)
    s_add_u32 m0, s81, 61440
    s_and_b32 s80, s80, 65535
    buffer_load_dwordx4 v80, s[8:11], s80 offen nt lds
    s_add_u32 s80, s80, 4096
    s_waitcnt vmcnt(6)
    s_waitcnt lgkmcnt(0)
    v_mov_b32 v126, 1
    ds_write_b32 v7, v126 offset:144
    s_lshl_b32 s76, s4, 12
    s_add_u32 s76, s76, 131072
    s_mul_i32 s77, s4, 147456
    s_lshl_b32 s6, s49, 6
    s_add_u32 s77, s77, s6
    s_add_u32 m0, s81, 65536
    s_and_b32 s80, s80, 65535
    buffer_load_dwordx4 v81, s[12:15], s80 offen nt lds
    s_add_u32 s80, s80, 4096
    v_lshrrev_b32 v90, 4, v1
    v_mul_u32_u24 v90, 1152, v90
    v_lshrrev_b32 v91, 7, v1
    v_lshlrev_b32 v91, 3, v91
    v_xor_b32 v91, v91, v1
    v_and_b32 v91, 12, v91
    v_lshl_add_u32 v90, v91, 2, v90
    s_add_u32 m0, s81, 69632
    s_and_b32 s80, s80, 65535
    buffer_load_dwordx4 v81, s[12:15], s80 offen nt lds
    s_add_u32 s80, s80, 4096
    v_lshlrev_b32 v82, 16, v102
    v_lshlrev_b32 v83, 16, v107
    v_lshlrev_b32 v84, 16, v112
    v_mul_f32 v85, v82, v82
    v_mul_f32 v85, 0xbdd2d3e8, v85
    v_mul_f32 v86, v85, v82
    v_mul_f32 v87, v85, v83
    v_mul_f32 v87, 0x40400000, v87
    v_and_b32 v89, 0xffff0000, v86
    v_sub_f32 v10, v86, v89
    v_cvt_pk_bf16_f32 v10, v89, v10
    v_and_b32 v89, 0xffff0000, v87
    v_sub_f32 v11, v87, v89
    v_cvt_pk_bf16_f32 v11, v89, v11
    v_perm_b32 v12, v87, v86, s38
    v_mul_f32 v85, v83, v83
    v_mul_f32 v85, 0xbdd2d3e8, v85
    v_add_f32 v86, 0xc0135761, v85
    v_mul_f32 v87, v86, v83
    v_fmac_f32 v86, 2.0, v85
    v_mul_f32 v86, v86, v82
    v_and_b32 v89, 0xffff0000, v86
    v_sub_f32 v13, v86, v89
    v_cvt_pk_bf16_f32 v13, v89, v13
    v_and_b32 v89, 0xffff0000, v87
    v_sub_f32 v14, v87, v89
    v_cvt_pk_bf16_f32 v14, v89, v14
    s_add_u32 m0, s81, 73728
    s_and_b32 s80, s80, 65535
    buffer_load_dwordx4 v81, s[12:15], s80 offen nt lds
    s_add_u32 s80, s80, 4096
    v_mul_f32 v86, v82, v84
    v_mul_f32 v87, v83, v84
    v_and_b32 v89, 0xffff0000, v86
    v_sub_f32 v15, v86, v89
    v_cvt_pk_bf16_f32 v15, v89, v15
    v_and_b32 v89, 0xffff0000, v87
    v_sub_f32 v16, v87, v89
    v_cvt_pk_bf16_f32 v16, v89, v16
    v_mov_b32 v17, 0
    v_and_b32 v82, 0xffff0000, v102
    v_and_b32 v83, 0xffff0000, v107
    v_and_b32 v84, 0xffff0000, v112
    v_mul_f32 v85, v82, v82
    v_mul_f32 v85, 0xbdd2d3e8, v85
    v_mul_f32 v86, v85, v82
    v_mul_f32 v87, v85, v83
    v_mul_f32 v87, 0x40400000, v87
    v_and_b32 v89, 0xffff0000, v86
    v_sub_f32 v18, v86, v89
    v_cvt_pk_bf16_f32 v18, v89, v18
    v_and_b32 v89, 0xffff0000, v87
    v_sub_f32 v19, v87, v89
    v_cvt_pk_bf16_f32 v19, v89, v19
    v_perm_b32 v20, v87, v86, s38
    v_mul_f32 v85, v83, v83
    v_mul_f32 v85, 0xbdd2d3e8, v85
    v_add_f32 v86, 0xc0135761, v85
    s_add_u32 m0, s81, 77824
    s_and_b32 s80, s80, 65535
    buffer_load_dwordx4 v81, s[12:15], s80 offen nt lds
    s_add_u32 s80, s80, 4096
    v_mul_f32 v87, v86, v83
    v_fmac_f32 v86, 2.0, v85
    v_mul_f32 v86, v86, v82
    v_and_b32 v89, 0xffff0000, v86
    v_sub_f32 v21, v86, v89
    v_cvt_pk_bf16_f32 v21, v89, v21
    v_and_b32 v89, 0xffff0000, v87
    v_sub_f32 v22, v87, v89
    v_cvt_pk_bf16_f32 v22, v89, v22
    v_mul_f32 v86, v82, v84
    v_mul_f32 v87, v83, v84
    v_and_b32 v89, 0xffff0000, v86
    v_sub_f32 v23, v86, v89
    v_cvt_pk_bf16_f32 v23, v89, v23
    v_and_b32 v89, 0xffff0000, v87
    v_sub_f32 v24, v87, v89
    v_cvt_pk_bf16_f32 v24, v89, v24
    v_mov_b32 v25, 0
    v_lshlrev_b32 v82, 16, v103
    v_lshlrev_b32 v83, 16, v108
    v_lshlrev_b32 v84, 16, v113
    v_mul_f32 v85, v82, v82
    v_mul_f32 v85, 0xbdd2d3e8, v85
    v_mul_f32 v86, v85, v82
    v_mul_f32 v87, v85, v83
    v_mul_f32 v87, 0x40400000, v87
    v_and_b32 v89, 0xffff0000, v86
    s_waitcnt vmcnt(4)
    v_mov_b32 v126, 1
    ds_write_b32 v7, v126 offset:48
    s_add_u32 m0, s81, 81920
    s_and_b32 s80, s80, 65535
    buffer_load_dwordx4 v81, s[12:15], s80 offen nt lds
    s_add_u32 s80, s80, 4096
    v_sub_f32 v26, v86, v89
    v_cvt_pk_bf16_f32 v26, v89, v26
    v_and_b32 v89, 0xffff0000, v87
    v_sub_f32 v27, v87, v89
    v_cvt_pk_bf16_f32 v27, v89, v27
    v_perm_b32 v28, v87, v86, s38
    v_mul_f32 v85, v83, v83
    v_mul_f32 v85, 0xbdd2d3e8, v85
    v_add_f32 v86, 0xc0135761, v85
    v_mul_f32 v87, v86, v83
    v_fmac_f32 v86, 2.0, v85
    v_mul_f32 v86, v86, v82
    v_and_b32 v89, 0xffff0000, v86
    v_sub_f32 v29, v86, v89
    v_cvt_pk_bf16_f32 v29, v89, v29
    v_and_b32 v89, 0xffff0000, v87
    v_sub_f32 v30, v87, v89
    v_cvt_pk_bf16_f32 v30, v89, v30
    v_mul_f32 v86, v82, v84
    v_mul_f32 v87, v83, v84
    v_and_b32 v89, 0xffff0000, v86
    v_sub_f32 v31, v86, v89
    v_cvt_pk_bf16_f32 v31, v89, v31
    v_and_b32 v89, 0xffff0000, v87
    v_sub_f32 v32, v87, v89
    v_cvt_pk_bf16_f32 v32, v89, v32
    v_mov_b32 v33, 0
    s_add_u32 m0, s81, 86016
    s_and_b32 s80, s80, 65535
    buffer_load_dwordx4 v81, s[12:15], s80 offen nt lds
    s_add_u32 s80, s80, 4096
    v_and_b32 v82, 0xffff0000, v103
    v_and_b32 v83, 0xffff0000, v108
    v_and_b32 v84, 0xffff0000, v113
    v_mul_f32 v85, v82, v82
    v_mul_f32 v85, 0xbdd2d3e8, v85
    v_mul_f32 v86, v85, v82
    v_mul_f32 v87, v85, v83
    v_mul_f32 v87, 0x40400000, v87
    v_and_b32 v89, 0xffff0000, v86
    v_sub_f32 v34, v86, v89
    v_cvt_pk_bf16_f32 v34, v89, v34
    v_and_b32 v89, 0xffff0000, v87
    v_sub_f32 v35, v87, v89
    v_cvt_pk_bf16_f32 v35, v89, v35
    v_perm_b32 v36, v87, v86, s38
    v_mul_f32 v85, v83, v83
    v_mul_f32 v85, 0xbdd2d3e8, v85
    v_add_f32 v86, 0xc0135761, v85
    v_mul_f32 v87, v86, v83
    v_fmac_f32 v86, 2.0, v85
    v_mul_f32 v86, v86, v82
    v_and_b32 v89, 0xffff0000, v86
    v_sub_f32 v37, v86, v89
    v_cvt_pk_bf16_f32 v37, v89, v37
    v_and_b32 v89, 0xffff0000, v87
    v_sub_f32 v38, v87, v89
    v_cvt_pk_bf16_f32 v38, v89, v38
    s_waitcnt vmcnt(6)
    s_add_u32 m0, s81, 90112
    s_and_b32 s80, s80, 65535
    buffer_load_dwordx4 v81, s[12:15], s80 offen nt lds
    s_add_u32 s80, s80, 4096
    v_mul_f32 v86, v82, v84
    v_mul_f32 v87, v83, v84
    v_and_b32 v89, 0xffff0000, v86
    v_sub_f32 v39, v86, v89
    v_cvt_pk_bf16_f32 v39, v89, v39
    v_and_b32 v89, 0xffff0000, v87
    v_sub_f32 v40, v87, v89
    v_cvt_pk_bf16_f32 v40, v89, v40
    v_mov_b32 v41, 0
    v_lshlrev_b32 v82, 16, v104
    v_lshlrev_b32 v83, 16, v109
    v_lshlrev_b32 v84, 16, v114
    v_mul_f32 v85, v82, v82
    v_mul_f32 v85, 0xbdd2d3e8, v85
    v_mul_f32 v86, v85, v82
    v_mul_f32 v87, v85, v83
    v_mul_f32 v87, 0x40400000, v87
    v_and_b32 v89, 0xffff0000, v86
    v_sub_f32 v42, v86, v89
    v_cvt_pk_bf16_f32 v42, v89, v42
    v_and_b32 v89, 0xffff0000, v87
    v_sub_f32 v43, v87, v89
    v_cvt_pk_bf16_f32 v43, v89, v43
    v_perm_b32 v44, v87, v86, s38
    v_mul_f32 v85, v83, v83
    v_mul_f32 v85, 0xbdd2d3e8, v85
    v_add_f32 v86, 0xc0135761, v85
    s_waitcnt vmcnt(6)
    s_add_u32 m0, s81, 94208
    s_and_b32 s80, s80, 65535
    buffer_load_dwordx4 v81, s[12:15], s80 offen nt lds
    s_add_u32 s80, s80, 4096
    v_mul_f32 v87, v86, v83
    v_fmac_f32 v86, 2.0, v85
    v_mul_f32 v86, v86, v82
    v_and_b32 v89, 0xffff0000, v86
    v_sub_f32 v45, v86, v89
    v_cvt_pk_bf16_f32 v45, v89, v45
    v_and_b32 v89, 0xffff0000, v87
    v_sub_f32 v46, v87, v89
    v_cvt_pk_bf16_f32 v46, v89, v46
    v_mul_f32 v86, v82, v84
    v_mul_f32 v87, v83, v84
    v_and_b32 v89, 0xffff0000, v86
    v_sub_f32 v47, v86, v89
    v_cvt_pk_bf16_f32 v47, v89, v47
    v_and_b32 v89, 0xffff0000, v87
    v_sub_f32 v48, v87, v89
    v_cvt_pk_bf16_f32 v48, v89, v48
    v_mov_b32 v49, 0
    v_and_b32 v82, 0xffff0000, v104
    v_and_b32 v83, 0xffff0000, v109
    v_and_b32 v84, 0xffff0000, v114
    v_mul_f32 v85, v82, v82
    v_mul_f32 v85, 0xbdd2d3e8, v85
    v_mul_f32 v86, v85, v82
    v_mul_f32 v87, v85, v83
    v_mul_f32 v87, 0x40400000, v87
    v_and_b32 v89, 0xffff0000, v86
    s_waitcnt vmcnt(6)
    s_add_u32 m0, s81, 98304
    s_and_b32 s80, s80, 65535
    buffer_load_dwordx4 v81, s[12:15], s80 offen nt lds
    s_add_u32 s80, s80, 4096
    v_sub_f32 v50, v86, v89
    v_cvt_pk_bf16_f32 v50, v89, v50
    v_and_b32 v89, 0xffff0000, v87
    v_sub_f32 v51, v87, v89
    v_cvt_pk_bf16_f32 v51, v89, v51
    v_perm_b32 v52, v87, v86, s38
    v_mul_f32 v85, v83, v83
    v_mul_f32 v85, 0xbdd2d3e8, v85
    v_add_f32 v86, 0xc0135761, v85
    v_mul_f32 v87, v86, v83
    v_fmac_f32 v86, 2.0, v85
    v_mul_f32 v86, v86, v82
    v_and_b32 v89, 0xffff0000, v86
    v_sub_f32 v53, v86, v89
    v_cvt_pk_bf16_f32 v53, v89, v53
    v_and_b32 v89, 0xffff0000, v87
    v_sub_f32 v54, v87, v89
    v_cvt_pk_bf16_f32 v54, v89, v54
    v_mul_f32 v86, v82, v84
    v_mul_f32 v87, v83, v84
    v_and_b32 v89, 0xffff0000, v86
    v_sub_f32 v55, v86, v89
    v_cvt_pk_bf16_f32 v55, v89, v55
    v_and_b32 v89, 0xffff0000, v87
    v_sub_f32 v56, v87, v89
    v_cvt_pk_bf16_f32 v56, v89, v56
    v_mov_b32 v57, 0
    s_waitcnt vmcnt(6)
    s_add_u32 m0, s81, 102400
    s_and_b32 s80, s80, 65535
    buffer_load_dwordx4 v81, s[12:15], s80 offen nt lds
    s_add_u32 s80, s80, 4096
    v_lshlrev_b32 v82, 16, v105
    v_lshlrev_b32 v83, 16, v110
    v_lshlrev_b32 v84, 16, v115
    v_mul_f32 v85, v82, v82
    v_mul_f32 v85, 0xbdd2d3e8, v85
    v_mul_f32 v86, v85, v82
    v_mul_f32 v87, v85, v83
    v_mul_f32 v87, 0x40400000, v87
    v_and_b32 v89, 0xffff0000, v86
    v_sub_f32 v58, v86, v89
    v_cvt_pk_bf16_f32 v58, v89, v58
    v_and_b32 v89, 0xffff0000, v87
    v_sub_f32 v59, v87, v89
    v_cvt_pk_bf16_f32 v59, v89, v59
    v_perm_b32 v60, v87, v86, s38
    v_mul_f32 v85, v83, v83
    v_mul_f32 v85, 0xbdd2d3e8, v85
    v_add_f32 v86, 0xc0135761, v85
    v_mul_f32 v87, v86, v83
    v_fmac_f32 v86, 2.0, v85
    v_mul_f32 v86, v86, v82
    v_and_b32 v89, 0xffff0000, v86
    v_sub_f32 v61, v86, v89
    v_cvt_pk_bf16_f32 v61, v89, v61
    v_and_b32 v89, 0xffff0000, v87
    v_sub_f32 v62, v87, v89
    v_cvt_pk_bf16_f32 v62, v89, v62
    s_waitcnt vmcnt(6)
    s_add_u32 m0, s81, 106496
    s_and_b32 s80, s80, 65535
    buffer_load_dwordx4 v81, s[12:15], s80 offen nt lds
    s_add_u32 s80, s80, 4096
    v_mul_f32 v86, v82, v84
    v_mul_f32 v87, v83, v84
    v_and_b32 v89, 0xffff0000, v86
    v_sub_f32 v63, v86, v89
    v_cvt_pk_bf16_f32 v63, v89, v63
    v_and_b32 v89, 0xffff0000, v87
    v_sub_f32 v64, v87, v89
    v_cvt_pk_bf16_f32 v64, v89, v64
    v_mov_b32 v65, 0
    v_and_b32 v82, 0xffff0000, v105
    v_and_b32 v83, 0xffff0000, v110
    v_and_b32 v84, 0xffff0000, v115
    v_mul_f32 v85, v82, v82
    v_mul_f32 v85, 0xbdd2d3e8, v85
    v_mul_f32 v86, v85, v82
    v_mul_f32 v87, v85, v83
    v_mul_f32 v87, 0x40400000, v87
    v_and_b32 v89, 0xffff0000, v86
    v_sub_f32 v66, v86, v89
    v_cvt_pk_bf16_f32 v66, v89, v66
    v_and_b32 v89, 0xffff0000, v87
    v_sub_f32 v67, v87, v89
    v_cvt_pk_bf16_f32 v67, v89, v67
    v_perm_b32 v68, v87, v86, s38
    v_mul_f32 v85, v83, v83
    v_mul_f32 v85, 0xbdd2d3e8, v85
    v_add_f32 v86, 0xc0135761, v85
    s_waitcnt vmcnt(6)
    s_add_u32 m0, s81, 110592
    s_and_b32 s80, s80, 65535
    buffer_load_dwordx4 v81, s[12:15], s80 offen nt lds
    s_add_u32 s80, s80, 4096
    v_mul_f32 v87, v86, v83
    v_fmac_f32 v86, 2.0, v85
    v_mul_f32 v86, v86, v82
    v_and_b32 v89, 0xffff0000, v86
    v_sub_f32 v69, v86, v89
    v_cvt_pk_bf16_f32 v69, v89, v69
    v_and_b32 v89, 0xffff0000, v87
    v_sub_f32 v70, v87, v89
    v_cvt_pk_bf16_f32 v70, v89, v70
    v_mul_f32 v86, v82, v84
    v_mul_f32 v87, v83, v84
    v_and_b32 v89, 0xffff0000, v86
    v_sub_f32 v71, v86, v89
    v_cvt_pk_bf16_f32 v71, v89, v71
    v_and_b32 v89, 0xffff0000, v87
    v_sub_f32 v72, v87, v89
    v_cvt_pk_bf16_f32 v72, v89, v72
    v_mov_b32 v73, 0
    v_lshlrev_b32 v82, 16, v106
    v_lshlrev_b32 v83, 16, v111
    v_lshlrev_b32 v84, 16, v116
    v_mul_f32 v85, v82, v82
    v_mul_f32 v85, 0xbdd2d3e8, v85
    v_mul_f32 v86, v85, v82
    v_mul_f32 v87, v85, v83
    v_mul_f32 v87, 0x40400000, v87
    v_and_b32 v89, 0xffff0000, v86
    s_waitcnt vmcnt(6)
    s_add_u32 m0, s81, 114688
    s_and_b32 s80, s80, 65535
    buffer_load_dwordx4 v81, s[12:15], s80 offen nt lds
    s_add_u32 s80, s80, 4096
    s_waitcnt vmcnt(6)
    v_mov_b32 v127, 163456
L_wf_1:
    ds_read_b128 v[122:125], v127 offset:16
    s_waitcnt lgkmcnt(0)
    v_and_b32 v122, v122, v123
    v_and_b32 v124, v124, v125
    v_and_b32 v122, v122, v124
    v_cmp_ne_u32 vcc, 0, v122
    s_cbranch_vccnz L_wf_1_d
    s_sub_u32 s55, s55, 1
    s_cbranch_scc1 L_end
    s_sleep 1
    s_branch L_wf_1
L_wf_1_d:
    v_mov_b32 v127, 163456
L_wf_2:
    ds_read_b128 v[122:125], v127 offset:144
    s_waitcnt lgkmcnt(0)
    v_and_b32 v122, v122, v123
    v_and_b32 v124, v124, v125
    v_and_b32 v122, v122, v124
    v_cmp_ne_u32 vcc, 0, v122
    s_cbranch_vccnz L_wf_2_d
    s_sub_u32 s55, s55, 1
    s_cbranch_scc1 L_end
    s_sleep 1
    s_branch L_wf_2
L_wf_2_d:
    s_add_u32 m0, s81, 118784
    s_and_b32 s80, s80, 65535
    buffer_load_dwordx4 v81, s[12:15], s80 offen nt lds
    s_add_u32 s80, s80, 4096
    s_waitcnt vmcnt(6)
    s_add_u32 m0, s81, 122880
    s_and_b32 s80, s80, 65535
    buffer_load_dwordx4 v81, s[12:15], s80 offen nt lds
    s_add_u32 s80, s80, 4096
    s_waitcnt vmcnt(6)
    s_add_u32 m0, s81, 126976
    s_and_b32 s80, s80, 65535
    buffer_load_dwordx4 v81, s[12:15], s80 offen nt lds
    s_add_u32 s80, s80, 4096
    v_sub_f32 v74, v86, v89
    v_cvt_pk_bf16_f32 v74, v89, v74
    v_and_b32 v89, 0xffff0000, v87
    v_sub_f32 v75, v87, v89
    v_cvt_pk_bf16_f32 v75, v89, v75
    v_perm_b32 v76, v87, v86, s38
    v_mul_f32 v85, v83, v83
    v_mul_f32 v85, 0xbdd2d3e8, v85
    v_add_f32 v86, 0xc0135761, v85
    v_mul_f32 v87, v86, v83
    v_fmac_f32 v86, 2.0, v85
    v_mul_f32 v86, v86, v82
    v_and_b32 v89, 0xffff0000, v86
    v_sub_f32 v77, v86, v89
    v_cvt_pk_bf16_f32 v77, v89, v77
    v_and_b32 v89, 0xffff0000, v87
    v_sub_f32 v78, v87, v89
    v_cvt_pk_bf16_f32 v78, v89, v78
    v_mul_f32 v86, v82, v84
    v_mul_f32 v87, v83, v84
    v_and_b32 v89, 0xffff0000, v86
    v_sub_f32 v79, v86, v89
    v_cvt_pk_bf16_f32 v79, v89, v79
    v_and_b32 v89, 0xffff0000, v87
    v_sub_f32 v80, v87, v89
    v_cvt_pk_bf16_f32 v80, v89, v80
    v_mov_b32 v81, 0
    s_waitcnt vmcnt(6)
    s_and_b32 s6, s49, 7
    s_lshl_b32 s6, s6, 2
    s_add_u32 s6, s6, s4
    s_mul_i32 s6, s6, 18432
    s_lshr_b32 s7, s49, 3
    s_lshl_b32 s7, s7, 6
    s_add_u32 s6, s6, s7
    s_add_u32 m0, s81, 147456
    s_add_u32 s6, s6, 1024
    buffer_load_dwordx4 v90, s[20:23], s6 offen nt lds
    s_waitcnt vmcnt(6)
    s_mov_b32 m0, s76
    s_add_u32 s76, s76, 1024
    buffer_load_dwordx4 v90, s[20:23], s77 offen nt lds
    s_add_u32 s77, s77, 18432
    s_waitcnt vmcnt(6)
    v_mov_b32 v126, 1
    ds_write_b32 v7, v126 offset:128
    s_mov_b32 m0, s76
    s_add_u32 s76, s76, 1024
    buffer_load_dwordx4 v90, s[20:23], s77 offen nt lds
    s_add_u32 s77, s77, 18432
    s_waitcnt vmcnt(6)
    s_mov_b32 m0, s76
    s_add_u32 s76, s76, 1024
    buffer_load_dwordx4 v90, s[20:23], s77 offen nt lds
    s_add_u32 s77, s77, 18432
    s_waitcnt vmcnt(6)
    s_mov_b32 m0, s76
    s_add_u32 s76, s76, 1024
    buffer_load_dwordx4 v90, s[20:23], s77 offen nt lds
    s_add_u32 s77, s77, 18432
    s_waitcnt vmcnt(6)
    s_lshl_b32 s76, s4, 12
    v_mov_b32 v127, 163456
L_wf_3:
    ds_read_b128 v[122:125], v127 offset:64
    s_waitcnt lgkmcnt(0)
    v_and_b32 v122, v122, v123
    v_and_b32 v124, v124, v125
    v_and_b32 v122, v122, v124
    v_cmp_ne_u32 vcc, 0, v122
    s_cbranch_vccnz L_wf_3_d
    s_sub_u32 s55, s55, 1
    s_cbranch_scc1 L_end
    s_sleep 1
    s_branch L_wf_3
L_wf_3_d:
    s_mov_b32 m0, s76
    s_add_u32 s76, s76, 1024
    buffer_load_dwordx4 v90, s[20:23], s77 offen nt lds
    s_add_u32 s77, s77, 18432
    s_waitcnt vmcnt(6)
    s_mov_b32 m0, s76
    s_add_u32 s76, s76, 1024
    buffer_load_dwordx4 v90, s[20:23], s77 offen nt lds
    s_add_u32 s77, s77, 18432
    s_waitcnt vmcnt(7)
    s_barrier
    s_mov_b32 m0, s76
    s_add_u32 s76, s76, 1024
    buffer_load_dwordx4 v90, s[20:23], s77 offen nt lds
    s_add_u32 s77, s77, 18432
    s_mov_b32 m0, s76
    s_add_u32 s76, s76, 1024
    buffer_load_dwordx4 v90, s[20:23], s77 offen nt lds
    s_add_u32 s77, s77, 18432
    v_bfe_u32 v82, v1, 4, 2
    v_lshrrev_b32 v84, 6, v1
    v_lshl_add_u32 v82, v84, 3, v82
    v_xor_b32 v84, s4, v84
    v_and_b32 v84, 1, v84
    v_lshlrev_b32 v84, 5, v84
    v_lshl_add_u32 v82, v82, 6, v84
    v_and_b32 v83, 12, v1
    v_lshl_add_u32 v82, v83, 1, v82
    v_add_u32 v83, 131072, v82
    s_waitcnt vmcnt(4)
    v_mov_b32 v126, 1
    ds_write_b32 v7, v126 offset:0
    v_bfe_u32 v90, v1, 2, 4
    v_lshl_add_u32 v91, v90, 6, v4
    v_add_u32 v91, 2304, v91
    v_add_u32 v92, 7680, v4
    v_lshrrev_b32 v90, 2, v90
    v_cmp_eq_u32 vcc, 0, v90
    s_nop 1
    v_cndmask_b32 v84, v92, v91, vcc
    v_cmp_eq_u32 vcc, 1, v90
    s_nop 1
    v_cndmask_b32 v85, v92, v91, vcc
    v_cmp_eq_u32 vcc, 2, v90
    s_nop 1
    v_cndmask_b32 v86, v92, v91, vcc
    v_cmp_eq_u32 vcc, 3, v90
    s_nop 1
    v_cndmask_b32 v87, v92, v91, vcc
    s_and_b32 s6, s49, 7
    s_lshl_b32 s6, s6, 7
    v_add_u32 v88, s6, v4
    v_mov_b32 v127, 163456
L_wf_4:
    ds_read_b128 v[122:125], v127 offset:0
    s_waitcnt lgkmcnt(0)
    v_and_b32 v122, v122, v123
    v_and_b32 v124, v124, v125
    v_and_b32 v122, v122, v124
    v_cmp_ne_u32 vcc, 0, v122
    s_cbranch_vccnz L_wf_4_d
    s_sub_u32 s55, s55, 1
    s_cbranch_scc1 L_end
    s_branch L_wf_4
L_wf_4_d:
    s_cmp_gt_u32 s3, 5
    s_cbranch_scc1 L_wx
    ds_read_b64_tr_b16 a[0:1], v83 offset:0
    ds_read_b64_tr_b16 a[2:3], v83 offset:256
    ds_read_b64_tr_b16 a[4:5], v83 offset:2048
    ds_read_b64_tr_b16 a[6:7], v83 offset:2304
    ds_read_b64_tr_b16 a[16:17], v83 offset:4096
    ds_read_b64_tr_b16 a[18:19], v83 offset:4352
    ds_read_b64_tr_b16 a[20:21], v83 offset:6144
    ds_read_b64_tr_b16 a[22:23], v83 offset:6400
    ds_read_b64_tr_b16 a[32:33], v83 offset:8192
    ds_read_b64_tr_b16 a[34:35], v83 offset:8448
    ds_read_b64_tr_b16 a[36:37], v83 offset:10240
    ds_read_b64_tr_b16 a[38:39], v83 offset:10496
    ds_read_b64_tr_b16 a[48:49], v83 offset:12288
    ds_read_b64_tr_b16 a[50:51], v83 offset:12544
    ds_read_b64_tr_b16 a[52:53], v83 offset:14336
    ds_read_b64_tr_b16 a[54:55], v83 offset:14592
    s_waitcnt vmcnt(0) lgkmcnt(0)
    s_barrier
    ds_read_b128 v[90:93], v84
    ds_read_b128 v[94:97], v85
    ds_read_b128 v[98:101], v86
    ds_read_b128 v[102:105], v87
    ds_read_b64_tr_b16 a[8:9], v82 offset:0
    ds_read_b64_tr_b16 a[10:11], v82 offset:256
    ds_read_b64_tr_b16 a[12:13], v82 offset:2048
    ds_read_b64_tr_b16 a[14:15], v82 offset:2304
    ds_read_b64_tr_b16 a[24:25], v82 offset:4096
    ds_read_b64_tr_b16 a[26:27], v82 offset:4352
    ds_read_b64_tr_b16 a[28:29], v82 offset:6144
    ds_read_b64_tr_b16 a[30:31], v82 offset:6400
    ds_read_b64_tr_b16 a[40:41], v82 offset:8192
    ds_read_b64_tr_b16 a[42:43], v82 offset:8448
    ds_read_b64_tr_b16 a[44:45], v82 offset:10240
    ds_read_b64_tr_b16 a[46:47], v82 offset:10496
    ds_read_b64_tr_b16 a[56:57], v82 offset:12288
    ds_read_b64_tr_b16 a[58:59], v82 offset:12544
    ds_read_b64_tr_b16 a[60:61], v82 offset:14336
    ds_read_b64_tr_b16 a[62:63], v82 offset:14592
    s_waitcnt lgkmcnt(14)
    v_mfma_f32_16x16x32_bf16 v[106:109], v[90:93], a[0:3], 0
    v_mfma_f32_16x16x32_bf16 v[110:113], v[90:93], a[4:7], 0
    v_mfma_f32_16x16x32_bf16 v[106:109], v[94:97], a[16:19], v[106:109]
    v_mfma_f32_16x16x32_bf16 v[110:113], v[94:97], a[20:23], v[110:113]
    v_mfma_f32_16x16x32_bf16 v[106:109], v[98:101], a[32:35], v[106:109]
    v_mfma_f32_16x16x32_bf16 v[110:113], v[98:101], a[36:39], v[110:113]
    v_mfma_f32_16x16x32_bf16 v[106:109], v[102:105], a[48:51], v[106:109]
    v_mfma_f32_16x16x32_bf16 v[110:113], v[102:105], a[52:55], v[110:113]
    s_waitcnt lgkmcnt(14)
    v_mfma_f32_16x16x32_bf16 v[114:117], v[90:93], a[8:11], 0
    s_waitcnt lgkmcnt(12)
    v_mfma_f32_16x16x32_bf16 v[118:121], v[90:93], a[12:15], 0
    s_waitcnt lgkmcnt(10)
    v_mfma_f32_16x16x32_bf16 v[114:117], v[94:97], a[24:27], v[114:117]
    s_waitcnt lgkmcnt(8)
    v_mfma_f32_16x16x32_bf16 v[118:121], v[94:97], a[28:31], v[118:121]
    s_waitcnt lgkmcnt(6)
    v_mfma_f32_16x16x32_bf16 v[114:117], v[98:101], a[40:43], v[114:117]
    s_waitcnt lgkmcnt(4)
    v_mfma_f32_16x16x32_bf16 v[118:121], v[98:101], a[44:47], v[118:121]
    s_waitcnt lgkmcnt(2)
    v_mfma_f32_16x16x32_bf16 v[114:117], v[102:105], a[56:59], v[114:117]
    s_waitcnt lgkmcnt(0)
    v_mfma_f32_16x16x32_bf16 v[118:121], v[102:105], a[60:63], v[118:121]
    s_branch L_wot
L_wx:
    ds_read_b64_tr_b16 a[0:1], v83 offset:16384
    ds_read_b64_tr_b16 a[2:3], v83 offset:16640
    ds_read_b64_tr_b16 a[4:5], v83 offset:18432
    ds_read_b64_tr_b16 a[6:7], v83 offset:18688
    s_waitcnt vmcnt(0) lgkmcnt(0)
L_wo:
    s_barrier
    s_cmp_lt_u32 s3, 6
    s_cbranch_scc1 L_wm
    ds_read_b128 v[90:93], v88 offset:2304
    ds_read_b128 v[94:97], v88 offset:2368
    s_waitcnt lgkmcnt(1)
    v_mfma_f32_16x16x32_bf16 v[118:121], v[90:93], a[0:3], 0
    s_waitcnt lgkmcnt(0)
    v_mfma_f32_16x16x32_bf16 v[118:121], v[94:97], a[4:7], v[118:121]
    s_nop 6
    s_branch L_wos
L_wm:
    ds_read_b128 v[90:93], v84
    ds_read_b128 v[94:97], v85
    ds_read_b128 v[98:101], v86
    ds_read_b128 v[102:105], v87
    s_waitcnt lgkmcnt(3)
    v_mfma_f32_16x16x32_bf16 v[106:109], v[90:93], a[0:3], 0
    v_mfma_f32_16x16x32_bf16 v[110:113], v[90:93], a[4:7], 0
    v_mfma_f32_16x16x32_bf16 v[114:117], v[90:93], a[8:11], 0
    v_mfma_f32_16x16x32_bf16 v[118:121], v[90:93], a[12:15], 0
    s_waitcnt lgkmcnt(2)
    v_mfma_f32_16x16x32_bf16 v[106:109], v[94:97], a[16:19], v[106:109]
    v_mfma_f32_16x16x32_bf16 v[110:113], v[94:97], a[20:23], v[110:113]
    v_mfma_f32_16x16x32_bf16 v[114:117], v[94:97], a[24:27], v[114:117]
    v_mfma_f32_16x16x32_bf16 v[118:121], v[94:97], a[28:31], v[118:121]
    s_waitcnt lgkmcnt(1)
    v_mfma_f32_16x16x32_bf16 v[106:109], v[98:101], a[32:35], v[106:109]
    v_mfma_f32_16x16x32_bf16 v[110:113], v[98:101], a[36:39], v[110:113]
    v_mfma_f32_16x16x32_bf16 v[114:117], v[98:101], a[40:43], v[114:117]
    v_mfma_f32_16x16x32_bf16 v[118:121], v[98:101], a[44:47], v[118:121]
    s_waitcnt lgkmcnt(0)
    v_mfma_f32_16x16x32_bf16 v[106:109], v[102:105], a[48:51], v[106:109]
    v_mfma_f32_16x16x32_bf16 v[110:113], v[102:105], a[52:55], v[110:113]
    v_mfma_f32_16x16x32_bf16 v[114:117], v[102:105], a[56:59], v[114:117]
    v_mfma_f32_16x16x32_bf16 v[118:121], v[102:105], a[60:63], v[118:121]
L_wot:
    s_nop 4
    v_add_f32 v106, v106, v111
    s_nop 1
    v_add_f32 v107, v116, v121
    v_add_f32 v106, v106, v107
    v_mov_b32 v107, v106
    s_nop 1
    v_permlane32_swap_b32 v106, v107
    v_add_f32 v106, v106, v107
    v_mov_b32 v107, v106
    s_nop 1
    v_permlane16_swap_b32 v106, v107
    v_add_f32 v118, v106, v107
    s_nop 1
L_wos:
    v_mov_b32_dpp v122, v118 quad_perm:[0,0,2,2] row_mask:0xf bank_mask:0xf
    v_mov_b32_dpp v123, v118 quad_perm:[1,1,3,3] row_mask:0xf bank_mask:0xf
    v_cvt_pk_bf16_f32 v118, v122, v123
    buffer_store_dword v118, v5, s[24:27], s62 offen sc1
L_cbar:
    v_lshl_add_u32 v102, v2, 1, s74
    v_add_u32 v105, 8192, v2
    s_cmp_lt_u32 s3, 4
    s_cbranch_scc1 L_cy
    s_lshl_b32 s6, s3, 6
    s_add_u32 s6, s6, 157440
    v_and_b32 v102, 28, v1
    v_lshrrev_b32 v103, 7, v1
    v_lshl_add_u32 v102, v102, 1, s6
    v_lshl_add_u32 v102, v103, 2, v102
L_cy:
    s_mov_b32 s4, 0x3f80
    s_mov_b32 s5, 0x3f800000
    v_and_b32 v106, 28, v1
    v_lshl_add_u32 v106, v106, 1, s74
    s_waitcnt vmcnt(0)
    v_mov_b32 v121, 0
    v_mov_b32 v119, 0x3f803f80
    s_barrier
L_gc:
    buffer_load_dword v82, v2, s[24:27], s63 offen offset:0 sc1
    buffer_load_dword v83, v2, s[24:27], s63 offen offset:2048 sc1
    buffer_load_dword v84, v2, s[24:27], s64 offen offset:0 sc1
    buffer_load_dword v85, v2, s[24:27], s64 offen offset:2048 sc1
    buffer_load_dword v86, v105, s[24:27], s63 offen offset:0 sc1
    buffer_load_dword v87, v105, s[24:27], s63 offen offset:2048 sc1
    buffer_load_dword v88, v105, s[24:27], s64 offen offset:0 sc1
    buffer_load_dword v89, v105, s[24:27], s64 offen offset:2048 sc1
    v_cndmask_b32 v118, v121, v119, s[70:71]
    v_cndmask_b32 v120, v121, v119, s[72:73]
    s_cmp_gt_u32 s3, 3
    s_cbranch_scc1 L_gx
    ds_read_b64 v[100:101], v102 offset:0
    s_waitcnt vmcnt(0) lgkmcnt(0)
    v_max3_u32 v90, v82, v83, v84
    v_max3_u32 v90, v90, v85, v86
    v_max3_u32 v90, v90, v87, v88
    v_max_u32 v90, v90, v89
    v_cmp_eq_u32 vcc, -1, v90
    s_cbranch_vccnz L_gc_f
    v_dot2c_f32_bf16 v100, s4, v82
    v_dot2c_f32_bf16 v101, s5, v82
    v_dot2c_f32_bf16 v100, s4, v83
    v_dot2c_f32_bf16 v101, s5, v83
    v_dot2c_f32_bf16 v100, s4, v84
    v_dot2c_f32_bf16 v101, s5, v84
    v_dot2c_f32_bf16 v100, s4, v85
    v_dot2c_f32_bf16 v101, s5, v85
    v_dot2c_f32_bf16 v100, s4, v86
    v_dot2c_f32_bf16 v101, s5, v86
    v_dot2c_f32_bf16 v100, s4, v87
    v_dot2c_f32_bf16 v101, s5, v87
    v_dot2c_f32_bf16 v100, s4, v88
    v_dot2c_f32_bf16 v101, s5, v88
    v_dot2c_f32_bf16 v100, s4, v89
    v_dot2c_f32_bf16 v101, s5, v89
    s_nop 2
    v_mul_f32 v83, v100, v100
    v_add_f32 v82, v100, v101
    v_fmac_f32 v83, v101, v101
    ds_write_b64 v102, v[100:101] offset:0
    s_nop 0
    v_permlane32_swap_b32 v82, v83
    v_add_f32 v82, v82, v83
    s_nop 1
    v_add_f32_dpp v82, v82, v82 row_ror:8 row_mask:0xf bank_mask:0xf
    s_nop 1
    v_add_f32_dpp v82, v82, v82 row_ror:4 row_mask:0xf bank_mask:0xf
    s_nop 1
    v_add_f32_dpp v82, v82, v82 row_ror:2 row_mask:0xf bank_mask:0xf
    s_nop 1
    v_add_f32_dpp v82, v82, v82 row_ror:1 row_mask:0xf bank_mask:0xf
    s_nop 1
    v_add_f32_dpp v82, v82, v82 row_bcast:15 row_mask:0xa bank_mask:0xf
    ds_write_b32 v9, v82
    s_branch L_gc_done
L_gx:
    ds_read_b32 v91, v102 offset:0
    v_mov_b32 v100, 0
    v_mov_b32 v101, 0
    s_waitcnt vmcnt(0) lgkmcnt(0)
    v_max3_u32 v90, v82, v83, v84
    v_max3_u32 v90, v90, v85, v86
    v_max3_u32 v90, v90, v87, v88
    v_max_u32 v90, v90, v89
    v_cmp_eq_u32 vcc, -1, v90
    s_cbranch_vccnz L_gc_f
    v_dot2c_f32_bf16 v100, s4, v82
    v_dot2c_f32_bf16 v101, s5, v82
    v_dot2c_f32_bf16 v100, s4, v83
    v_dot2c_f32_bf16 v101, s5, v83
    v_dot2c_f32_bf16 v100, s4, v84
    v_dot2c_f32_bf16 v101, s5, v84
    v_dot2c_f32_bf16 v100, s4, v85
    v_dot2c_f32_bf16 v101, s5, v85
    v_dot2c_f32_bf16 v100, s4, v86
    v_dot2c_f32_bf16 v101, s5, v86
    v_dot2c_f32_bf16 v100, s4, v87
    v_dot2c_f32_bf16 v101, s5, v87
    v_dot2c_f32_bf16 v100, s4, v88
    v_dot2c_f32_bf16 v101, s5, v88
    v_dot2c_f32_bf16 v100, s4, v89
    v_dot2c_f32_bf16 v101, s5, v89
    s_nop 2
    v_permlane32_swap_b32 v100, v101
    v_add_f32 v100, v100, v101
    v_mov_b32 v101, v100
    s_nop 1
    v_permlane16_swap_b32 v100, v101
    v_add_f32 v100, v100, v101
    s_nop 1
    v_add_f32_dpp v100, v100, v100 row_ror:8 row_mask:0xf bank_mask:0xf
    v_add_f32 v100, v100, v91
    v_mul_f32 v101, v100, v100
    ds_write_b32 v102, v100 offset:0
    v_mov_b32 v82, v100
    s_nop 1
    v_permlane32_swap_b32 v82, v101
    v_add_f32 v82, v82, v101
    s_nop 1
    v_add_f32_dpp v82, v82, v82 row_ror:4 row_mask:0xf bank_mask:0xf
    s_nop 1
    v_add_f32_dpp v82, v82, v82 row_ror:2 row_mask:0xf bank_mask:0xf
    s_nop 1
    v_add_f32_dpp v82, v82, v82 row_ror:1 row_mask:0xf bank_mask:0xf
    ds_write_b32 v9, v82
L_gc_done:
    s_waitcnt lgkmcnt(0)
    s_barrier
    ds_read_b64 v[82:83], v106 offset:5632
    ds_read_b32 v99, v8
    s_cmp_lg_u32 s53, 0
    s_cbranch_scc1 L_notouch
    s_cmp_gt_u32 s3, 3
    s_cbranch_scc1 L_notouch
    v_lshlrev_b32 v100, 4, v1
    s_add_u32 s6, s57, 131072
    s_add_u32 s7, s60, 397312
    v_and_b32 v101, 0x7c0, v100
    buffer_load_dword v127, v100, s[24:27], s6 offen sc1
    buffer_load_dword v127, v101, s[24:27], s7 offen sc1
    s_add_u32 s7, s61, 397312
    v_mov_b32 v101, 0
    buffer_load_dword v127, v101, s[24:27], s7 offen sc1
L_notouch:
    s_waitcnt lgkmcnt(0)
    v_add_f32_dpp v82, v82, v82 row_ror:4 row_mask:0xf bank_mask:0xf
    v_add_f32_dpp v83, v83, v83 row_ror:4 row_mask:0xf bank_mask:0xf
    s_nop 0
    v_add_f32_dpp v82, v82, v82 row_ror:2 row_mask:0xf bank_mask:0xf
    v_add_f32_dpp v83, v83, v83 row_ror:2 row_mask:0xf bank_mask:0xf
    s_nop 0
    v_add_f32_dpp v82, v82, v82 row_ror:1 row_mask:0xf bank_mask:0xf
    v_add_f32_dpp v83, v83, v83 row_ror:1 row_mask:0xf bank_mask:0xf
    v_mul_f32 v82, 0x3ae38e39, v82
    v_mul_f32 v83, 0x3ae38e39, v83
    v_fma_f32 v83, -v82, v82, v83
    v_max_f32 v83, 0, v83
    v_mul_f32 v83, 0x3f800054, v83
    v_add_f32 v84, 0x2edbe6ff, v83
    v_rsq_f32 v84, v84
    v_sub_f32 v99, v99, v82
    v_mul_f32 v99, v99, v84
    v_cvt_pk_bf16_f32 v99, v99, v99
    v_cndmask_b32 v117, v121, v99, s[70:71]
    v_cndmask_b32 v119, v121, v99, s[72:73]
    v_and_b32 v82, 0xffff0000, v117
    v_mul_f32 v83, v82, v82
    v_mul_f32 v84, v83, v82
    v_and_b32 v85, 0xffff0000, v83
    v_perm_b32 v115, v83, v83, s38
    v_and_b32 v86, 0xffff0000, v84
    v_sub_f32 v85, v83, v85
    v_sub_f32 v86, v84, v86
    v_perm_b32 v114, v84, v84, s38
    v_cvt_pk_bf16_f32 v116, v86, v85
    s_nop 1
    s_setprio 0
    v_mfma_f32_32x32x16_bf16 v[82:97], v[114:117], v[10:13], 0
    v_mfma_f32_32x32x16_bf16 v[82:97], v[118:121], v[14:17], v[82:97]
    v_mfma_f32_32x32x16_bf16 v[98:113], v[114:117], v[18:21], 0
    s_nop 10
    v_exp_f32 v82, v82
    v_exp_f32 v83, v83
    v_exp_f32 v84, v84
    v_exp_f32 v85, v85
    v_exp_f32 v86, v86
    v_pk_add_f32 v[82:83], v[82:83], 1.0 op_sel_hi:[1,0]
    v_pk_add_f32 v[84:85], v[84:85], 1.0 op_sel_hi:[1,0]
    v_add_f32 v86, 1.0, v86
    v_mfma_f32_32x32x16_bf16 v[98:113], v[118:121], v[22:25], v[98:113]
    v_rcp_f32 v82, v82
    v_rcp_f32 v83, v83
    v_rcp_f32 v84, v84
    v_rcp_f32 v85, v85
    v_rcp_f32 v86, v86
    v_pk_mul_f32 v[122:123], v[82:83], v[88:89]
    v_pk_mul_f32 v[124:125], v[84:85], v[90:91]
    v_mul_f32 v126, v86, v92
    v_mfma_f32_32x32x16_bf16 v[82:97], v[114:117], v[26:29], 0
    v_exp_f32 v98, v98
    v_exp_f32 v99, v99
    v_exp_f32 v100, v100
    v_exp_f32 v101, v101
    v_exp_f32 v102, v102
    v_pk_add_f32 v[98:99], v[98:99], 1.0 op_sel_hi:[1,0]
    v_pk_add_f32 v[100:101], v[100:101], 1.0 op_sel_hi:[1,0]
    v_add_f32 v102, 1.0, v102
    v_mfma_f32_32x32x16_bf16 v[82:97], v[118:121], v[30:33], v[82:97]
    v_rcp_f32 v98, v98
    v_rcp_f32 v99, v99
    v_rcp_f32 v100, v100
    v_rcp_f32 v101, v101
    v_rcp_f32 v102, v102
    v_pk_fma_f32 v[122:123], v[98:99], v[104:105], v[122:123]
    v_pk_fma_f32 v[124:125], v[100:101], v[106:107], v[124:125]
    v_fmac_f32 v126, v102, v108
    v_mfma_f32_32x32x16_bf16 v[98:113], v[114:117], v[34:37], 0
    v_exp_f32 v82, v82
    v_exp_f32 v83, v83
    v_exp_f32 v84, v84
    v_exp_f32 v85, v85
    v_exp_f32 v86, v86
    v_pk_add_f32 v[82:83], v[82:83], 1.0 op_sel_hi:[1,0]
    v_pk_add_f32 v[84:85], v[84:85], 1.0 op_sel_hi:[1,0]
    v_add_f32 v86, 1.0, v86
    v_mfma_f32_32x32x16_bf16 v[98:113], v[118:121], v[38:41], v[98:113]
    v_rcp_f32 v82, v82
    v_rcp_f32 v83, v83
    v_rcp_f32 v84, v84
    v_rcp_f32 v85, v85
    v_rcp_f32 v86, v86
    v_pk_fma_f32 v[122:123], v[82:83], v[88:89], v[122:123]
    v_pk_fma_f32 v[124:125], v[84:85], v[90:91], v[124:125]
    v_fmac_f32 v126, v86, v92
    v_mfma_f32_32x32x16_bf16 v[82:97], v[114:117], v[42:45], 0
    v_exp_f32 v98, v98
    v_exp_f32 v99, v99
    v_exp_f32 v100, v100
    v_exp_f32 v101, v101
    v_exp_f32 v102, v102
    v_pk_add_f32 v[98:99], v[98:99], 1.0 op_sel_hi:[1,0]
    v_pk_add_f32 v[100:101], v[100:101], 1.0 op_sel_hi:[1,0]
    v_add_f32 v102, 1.0, v102
    v_mfma_f32_32x32x16_bf16 v[82:97], v[118:121], v[46:49], v[82:97]
    v_rcp_f32 v98, v98
    v_rcp_f32 v99, v99
    v_rcp_f32 v100, v100
    v_rcp_f32 v101, v101
    v_rcp_f32 v102, v102
    v_pk_fma_f32 v[122:123], v[98:99], v[104:105], v[122:123]
    v_pk_fma_f32 v[124:125], v[100:101], v[106:107], v[124:125]
    v_fmac_f32 v126, v102, v108
    v_mfma_f32_32x32x16_bf16 v[98:113], v[114:117], v[50:53], 0
    v_exp_f32 v82, v82
    v_exp_f32 v83, v83
    v_exp_f32 v84, v84
    v_exp_f32 v85, v85
    v_exp_f32 v86, v86
    v_pk_add_f32 v[82:83], v[82:83], 1.0 op_sel_hi:[1,0]
    v_pk_add_f32 v[84:85], v[84:85], 1.0 op_sel_hi:[1,0]
    v_add_f32 v86, 1.0, v86
    v_mfma_f32_32x32x16_bf16 v[98:113], v[118:121], v[54:57], v[98:113]
    v_rcp_f32 v82, v82
    v_rcp_f32 v83, v83
    v_rcp_f32 v84, v84
    v_rcp_f32 v85, v85
    v_rcp_f32 v86, v86
    v_pk_fma_f32 v[122:123], v[82:83], v[88:89], v[122:123]
    v_pk_fma_f32 v[124:125], v[84:85], v[90:91], v[124:125]
    v_fmac_f32 v126, v86, v92
    v_mfma_f32_32x32x16_bf16 v[82:97], v[114:117], v[58:61], 0
    v_exp_f32 v98, v98
    v_exp_f32 v99, v99
    v_exp_f32 v100, v100
    v_exp_f32 v101, v101
    v_exp_f32 v102, v102
    v_pk_add_f32 v[98:99], v[98:99], 1.0 op_sel_hi:[1,0]
    v_pk_add_f32 v[100:101], v[100:101], 1.0 op_sel_hi:[1,0]
    v_add_f32 v102, 1.0, v102
    v_mfma_f32_32x32x16_bf16 v[82:97], v[118:121], v[62:65], v[82:97]
    v_rcp_f32 v98, v98
    v_rcp_f32 v99, v99
    v_rcp_f32 v100, v100
    v_rcp_f32 v101, v101
    v_rcp_f32 v102, v102
    v_pk_fma_f32 v[122:123], v[98:99], v[104:105], v[122:123]
    v_pk_fma_f32 v[124:125], v[100:101], v[106:107], v[124:125]
    v_fmac_f32 v126, v102, v108
    v_mfma_f32_32x32x16_bf16 v[98:113], v[114:117], v[66:69], 0
    v_exp_f32 v82, v82
    v_exp_f32 v83, v83
    v_exp_f32 v84, v84
    v_exp_f32 v85, v85
    v_exp_f32 v86, v86
    v_pk_add_f32 v[82:83], v[82:83], 1.0 op_sel_hi:[1,0]
    v_pk_add_f32 v[84:85], v[84:85], 1.0 op_sel_hi:[1,0]
    v_add_f32 v86, 1.0, v86
    v_mfma_f32_32x32x16_bf16 v[98:113], v[118:121], v[70:73], v[98:113]
    v_rcp_f32 v82, v82
    v_rcp_f32 v83, v83
    v_rcp_f32 v84, v84
    v_rcp_f32 v85, v85
    v_rcp_f32 v86, v86
    v_pk_fma_f32 v[122:123], v[82:83], v[88:89], v[122:123]
    v_pk_fma_f32 v[124:125], v[84:85], v[90:91], v[124:125]
    v_fmac_f32 v126, v86, v92
    v_mfma_f32_32x32x16_bf16 v[82:97], v[114:117], v[74:77], 0
    v_exp_f32 v98, v98
    v_exp_f32 v99, v99
    v_exp_f32 v100, v100
    v_exp_f32 v101, v101
    v_exp_f32 v102, v102
    v_pk_add_f32 v[98:99], v[98:99], 1.0 op_sel_hi:[1,0]
    v_pk_add_f32 v[100:101], v[100:101], 1.0 op_sel_hi:[1,0]
    v_add_f32 v102, 1.0, v102
    v_mfma_f32_32x32x16_bf16 v[82:97], v[118:121], v[78:81], v[82:97]
    v_rcp_f32 v98, v98
    v_rcp_f32 v99, v99
    v_rcp_f32 v100, v100
    v_rcp_f32 v101, v101
    v_rcp_f32 v102, v102
    v_pk_fma_f32 v[122:123], v[98:99], v[104:105], v[122:123]
    v_pk_fma_f32 v[124:125], v[100:101], v[106:107], v[124:125]
    v_fmac_f32 v126, v102, v108
    s_nop 0
    v_exp_f32 v82, v82
    v_exp_f32 v83, v83
    v_exp_f32 v84, v84
    v_exp_f32 v85, v85
    v_exp_f32 v86, v86
    v_pk_add_f32 v[82:83], v[82:83], 1.0 op_sel_hi:[1,0]
    v_pk_add_f32 v[84:85], v[84:85], 1.0 op_sel_hi:[1,0]
    v_add_f32 v86, 1.0, v86
    v_rcp_f32 v82, v82
    v_rcp_f32 v83, v83
    v_rcp_f32 v84, v84
    v_rcp_f32 v85, v85
    v_rcp_f32 v86, v86
    v_pk_fma_f32 v[122:123], v[82:83], v[88:89], v[122:123]
    v_pk_fma_f32 v[124:125], v[84:85], v[90:91], v[124:125]
    v_fmac_f32 v126, v86, v92
L_mend:
    v_mov_b32 v102, v126
    v_lshrrev_b32 v98, 6, v1
    v_and_b32 v99, 1, v98
    v_permlane32_swap_b32 v122, v123
    v_permlane32_swap_b32 v124, v125
    v_permlane32_swap_b32 v126, v102
    v_add_f32 v122, v122, v123
    v_add_f32 v124, v124, v125
    v_add_f32 v126, v126, v102
    v_mov_b32 v102, v126
    v_lshrrev_b32 v98, 1, v98
    v_lshl_add_u32 v98, v99, 1, v98
    v_permlane16_swap_b32 v122, v124
    v_permlane16_swap_b32 v126, v102
    v_add_f32 v122, v122, v124
    v_add_f32 v126, v126, v102
    s_lshl_b32 s6, s3, 2
    v_add_f32_dpp v122, v122, v122 row_ror:8 row_mask:0xf bank_mask:0xf
    v_add_f32_dpp v126, v126, v126 row_ror:8 row_mask:0xf bank_mask:0xf
    s_add_u32 s6, s6, 162560
    v_add_f32_dpp v122, v122, v122 row_ror:4 row_mask:0xf bank_mask:0xf
    v_add_f32_dpp v126, v126, v126 row_ror:4 row_mask:0xf bank_mask:0xf
    v_lshl_add_u32 v98, v98, 5, s6
    v_add_f32_dpp v122, v122, v122 row_ror:2 row_mask:0xf bank_mask:0xf
    v_add_f32_dpp v126, v126, v126 row_ror:2 row_mask:0xf bank_mask:0xf
    v_mov_b32 v99, s6
    v_add_f32_dpp v122, v122, v122 row_ror:1 row_mask:0xf bank_mask:0xf
    v_add_f32_dpp v126, v126, v126 row_ror:1 row_mask:0xf bank_mask:0xf
    ds_write_b32 v98, v122
    ds_write_b32 v99, v126 offset:128
    s_cmp_lg_u32 s3, 0
    s_cbranch_scc1 L_nofin
    v_and_b32 v98, 28, v1
    v_lshl_add_u32 v99, v98, 3, s74
    s_lshl_b32 s6, s51, 2
    s_add_u32 s6, s6, 155648
    v_add_u32 v100, s6, v98
    ds_read_b32 v100, v100
    v_lshrrev_b32 v101, 5, v1
    v_mul_u32_u24 v101, 2560, v101
    v_add_u32 v101, v101, v98
    s_mul_i32 s6, s45, 576
    s_add_u32 s6, s6, s51
    s_lshl_b32 s6, s6, 1
    v_lshrrev_b32 v103, 1, v1
    v_add_u32 v103, s6, v103
    s_lshl_b32 s6, 1, s52
    s_sub_u32 s6, s6, 1
    s_mul_i32 s7, s6, 0x01010101
    s_lshl_b32 s5, s67, 16
    s_waitcnt lgkmcnt(0)
    v_add_f32 v100, s5, v100
    s_barrier
    ds_read_b128 v[82:85], v99 offset:6912
    ds_read_b128 v[86:89], v99 offset:6928
    s_waitcnt lgkmcnt(0)
    v_pk_add_f32 v[82:83], v[82:83], v[84:85]
    v_pk_add_f32 v[86:87], v[86:87], v[88:89]
    v_pk_add_f32 v[82:83], v[82:83], v[86:87]
    v_add_f32 v82, v82, v100
    v_add_f32 v82, v82, v83
    s_cmp_eq_u32 s53, 0
    s_cbranch_scc1 L_xd
    s_mov_b32 exec_lo, s6
    s_mov_b32 exec_hi, 0
    v_cvt_pk_bf16_f32 v82, v82, v82
    global_store_short v103, v82, s[28:29]
    s_endpgm
L_xd:
    s_mov_b32 exec_lo, s7
    s_mov_b32 exec_hi, s7
    buffer_store_dword v82, v101, s[24:27], s66 offen sc1
    s_mov_b64 exec, -1
    s_branch L_dpace
L_nofin:
    s_waitcnt lgkmcnt(0)
    s_barrier
    s_cmp_lg_u32 s53, 0
    s_cbranch_scc1 L_fin
L_dpace:
    s_load_dwordx2 s[28:29], s[0:1], 80
    v_lshl_add_u32 v102, v2, 1, s74
    v_add_u32 v103, s74, v2
    v_lshlrev_b32 v104, 1, v2
    v_mov_b32 v100, 0
    v_mov_b32 v101, 0
    v_mov_b32 v105, 163696
    ds_read_b64 v[106:107], v105
    s_waitcnt lgkmcnt(0)
    v_readfirstlane_b32 s40, v106
    v_readfirstlane_b32 s54, v107
    s_add_u32 s56, s56, 131072
    s_add_u32 s57, s57, 131072
    s_add_u32 s58, s58, 397312
    s_add_u32 s59, s59, 397312
    s_add_u32 s60, s60, 397312
    s_add_u32 s61, s61, 397312
    s_add_u32 s62, s62, 397312
    s_add_u32 s63, s63, 397312
    s_add_u32 s64, s64, 397312
    s_mov_b32 s53, 1
    s_waitcnt vmcnt(0)
    v_lshrrev_b32 v126, 6, v1
    v_lshlrev_b32 v126, 3, v126
    v_sub_u32 v126, v3, v126
    v_mov_b32 v127, s74
    s_barrier
    s_cmp_gt_u32 s3, 4
    s_cbranch_scc1 L_gd_done
    s_cmp_eq_u32 s3, 4
    s_cselect_b32 exec_hi, 0, -1
L_gd:
    buffer_load_dwordx2 v[100:101], v104, s[24:27], s65 offen sc1
    s_waitcnt vmcnt(0)
    v_max_u32 v84, v100, v101
    v_cmp_eq_u32 vcc, -1, v84
    s_cbranch_vccnz L_gd_f
    s_mov_b64 exec, -1
    v_mul_f32 v83, v100, v100
    v_add_f32 v82, v100, v101
    v_fmac_f32 v83, v101, v101
    v_cvt_pk_bf16_f32 v84, v100, v101
    ds_write_b64 v102, v[100:101] offset:0
    v_permlane32_swap_b32 v82, v83
    v_add_f32 v82, v82, v83
    v_lshlrev_b32 v86, 16, v84
    v_and_b32 v87, 0xffff0000, v84
    v_add_f32_dpp v82, v82, v82 row_ror:8 row_mask:0xf bank_mask:0xf
    ds_write_b32 v103, v84 offset:3328
    v_sub_f32 v86, v100, v86
    v_add_f32_dpp v82, v82, v82 row_ror:4 row_mask:0xf bank_mask:0xf
    v_sub_f32 v87, v101, v87
    v_cvt_pk_bf16_f32 v86, v86, v87
    v_add_f32_dpp v82, v82, v82 row_ror:2 row_mask:0xf bank_mask:0xf
    ds_write_b32 v103, v86 offset:5760
    s_nop 0
    v_add_f32_dpp v82, v82, v82 row_ror:1 row_mask:0xf bank_mask:0xf
    s_nop 1
    v_add_f32_dpp v82, v82, v82 row_bcast:15 row_mask:0xa bank_mask:0xf
    ds_write_b32 v9, v82
    s_waitcnt lgkmcnt(0)
L_gd_done:
    s_barrier
    s_cmp_lt_u32 s3, 4
    s_cbranch_scc1 L_attn
    ds_read_b128 v[82:85], v3 offset:0
    ds_read_b128 v[86:89], v3 offset:64
    ds_read_b128 v[90:93], v3 offset:128
    ds_read_b128 v[94:97], v3 offset:192
    ds_read_b64 v[98:99], v126 offset:256
    ds_read_b128 v[102:105], v127 offset:5632
    ds_read_b128 v[106:109], v127 offset:5648
    ds_read_b128 v[110:113], v127 offset:5664
    s_waitcnt lgkmcnt(7)
    v_mfma_f32_16x16x32_bf16 v[118:121], v[82:85], a[64:67], 0
    v_mfma_f32_16x16x32_bf16 v[122:125], v[82:85], a[80:83], 0
    s_waitcnt lgkmcnt(6)
    v_mfma_f32_16x16x32_bf16 v[118:121], v[86:89], a[68:71], v[118:121]
    v_mfma_f32_16x16x32_bf16 v[122:125], v[86:89], a[84:87], v[122:125]
    s_waitcnt lgkmcnt(5)
    v_mfma_f32_16x16x32_bf16 v[118:121], v[90:93], a[72:75], v[118:121]
    v_mfma_f32_16x16x32_bf16 v[122:125], v[90:93], a[88:91], v[122:125]
    s_waitcnt lgkmcnt(4)
    v_mfma_f32_16x16x32_bf16 v[118:121], v[94:97], a[76:79], v[118:121]
    v_mfma_f32_16x16x32_bf16 v[122:125], v[94:97], a[92:95], v[122:125]
    s_waitcnt lgkmcnt(3)
    v_mfma_f32_16x16x16_bf16 v[118:121], v[98:99], a[96:97], v[118:121]
    v_mfma_f32_16x16x16_bf16 v[122:125], v[98:99], a[98:99], v[122:125]
    s_waitcnt lgkmcnt(0)
    v_pk_add_f32 v[102:103], v[102:103], v[104:105]
    v_pk_add_f32 v[106:107], v[106:107], v[108:109]
    v_pk_add_f32 v[102:103], v[102:103], v[110:111]
    v_pk_add_f32 v[102:103], v[102:103], v[106:107]
    v_mul_f32 v102, 0x3ae38e39, v102
    v_mul_f32 v103, 0x3ae38e39, v103
    v_fma_f32 v103, -v102, v102, v103
    v_max_f32 v103, 0, v103
    v_add_f32 v104, 0x3727c5ac, v103
    v_rsq_f32 v104, v104
    v_add_f32 v118, v118, v119
    v_fma_f32 v118, -v102, v120, v118
    v_add_f32 v122, v122, v123
    v_fma_f32 v122, -v102, v124, v122
    v_mul_f32 v104, 0x3e0293ee, v104
    s_mov_b64 exec, 0xffff
    v_mul_f32 v118, v118, v104
    v_mul_f32 v122, v122, v104
    v_and_b32 v118, 0xfffff000, v118
    v_and_b32 v122, 0xfffff000, v122
    v_or_b32 v118, s40, v118
    v_or_b32 v122, s40, v122
    buffer_store_dword v118, v1, s[24:27], s56 offen
    buffer_store_dword v122, v1, s[24:27], s56 offen offset:64
    s_cmp_lg_u32 s54, 0
    s_cbranch_scc1 L_q1_5
    s_add_u32 s78, s56, 262144
    buffer_store_dword v118, v1, s[24:27], s78 offen sc1
    buffer_store_dword v122, v1, s[24:27], s78 offen offset:64 sc1
L_q1_5:
    s_mov_b64 exec, -1
    v_bfe_u32 v90, v1, 2, 4
    v_lshl_add_u32 v91, v90, 6, v4
    v_add_u32 v91, 2304, v91
    v_add_u32 v92, 7680, v4
    v_lshrrev_b32 v90, 2, v90
    v_cmp_eq_u32 vcc, 0, v90
    s_nop 1
    v_cndmask_b32 v84, v92, v91, vcc
    v_cmp_eq_u32 vcc, 1, v90
    s_nop 1
    v_cndmask_b32 v85, v92, v91, vcc
    v_cmp_eq_u32 vcc, 2, v90
    s_nop 1
    v_cndmask_b32 v86, v92, v91, vcc
    v_cmp_eq_u32 vcc, 3, v90
    s_nop 1
    v_cndmask_b32 v87, v92, v91, vcc
    s_and_b32 s6, s49, 7
    s_lshl_b32 s6, s6, 7
    v_add_u32 v88, s6, v4
    s_barrier
    s_barrier
    s_branch L_wo
L_gc_f:
    s_sub_u32 s55, s55, 1
    s_cbranch_scc1 L_end
    s_branch L_gc
L_gd_f:
    s_sub_u32 s55, s55, 1
    s_cbranch_scc1 L_end
    s_branch L_gd
L_fin:
L_end:
    s_endpgm
L_centry:
    v_and_b32 v83, 63, v0
    v_lshlrev_b32 v2, 2, v0
    v_lshlrev_b32 v1, 2, v83
    v_and_b32 v84, 15, v83
    v_lshrrev_b32 v85, 4, v83
    s_lshr_b32 s45, s2, 7
    s_bfe_u32 s49, s2, 0x40003
    s_mul_i32 s6, s45, 1152
    v_add_u32 v98, s6, v2
    v_and_b32 v100, 31, v83
    v_lshl_add_u32 v99, v100, 2, s6
    v_mov_b32 v101, 528384
    s_waitcnt lgkmcnt(0)
    global_load_dword v94, v98, s[56:57]
    global_load_dword v95, v99, s[56:57] offset:1024
    global_load_dword v96, v101, s[42:43] sc1
    s_getpc_b64 s[4:5]
L_pc:
    s_sub_u32 s4, s4, L_pc-interleave_layers__sliding_block_cached__mixer_token_mlp__decode_kernel
    s_subb_u32 s5, s5, 0
    s_lshr_b32 s7, s2, 3
    s_lshl_b32 s7, s7, 2
    s_add_u32 s7, s7, s3
    s_mul_i32 s7, s7, 192
    s_mov_b64 exec, 7
    v_lshl_add_u32 v97, v83, 6, s7
    v_min_u32 v97, L_last-interleave_layers__sliding_block_cached__mixer_token_mlp__decode_kernel, v97
    global_load_dword v80, v97, s[4:5]
    s_mov_b64 exec, -1
    s_cmp_lg_u32 s3, 0
    s_cbranch_scc1 L_noinit
    v_mov_b32 v86, 0
    v_add_u32 v87, 155648, v1
    ds_write_b32 v87, v86 offset:7808
    ds_write_b32 v87, v86 offset:7680
    v_mov_b32 v86, 0x3f803f80
    ds_write_b32 v87, v86 offset:7168
    ds_write_b32 v87, v86 offset:7424
L_noinit:
    s_waitcnt lgkmcnt(0)
    s_lshr_b32 s4, s47, 1
    s_lshl_b32 s5, s45, 4
    s_add_u32 s5, s5, s48
    s_and_b32 s7, s3, 3
    s_lshl_b32 s6, s7, 2
    s_add_u32 s6, s6, 163456
    v_mov_b32 v7, s6
    s_mov_b64 s[30:31], s[68:69]
    s_mov_b64 s[32:33], s[70:71]
    s_mov_b64 s[34:35], s[72:73]
    s_mov_b64 s[36:37], s[74:75]
    s_mul_i32 s6, s44, 589824
    s_add_u32 s20, s64, s6
    s_addc_u32 s21, s65, 0
    s_sub_u32 s22, 4718592, s6
    s_mov_b32 s23, 0x20000
    s_mov_b32 s24, s42
    s_mov_b32 s25, s43
    s_mov_b32 s26, 2097152
    s_mov_b32 s27, 0x20000
    s_load_dword s67, s[36:37], 0
    s_getreg_b32 s75, hwreg(HW_REG_XCC_ID, 0, 4)
    s_mov_b32 s53, 0
    s_mov_b32 s54, 0
    s_mov_b32 s55, 4194304
    s_mov_b32 s39, 0
    s_mov_b32 s74, 155648
    s_lshl_b32 s57, s5, 12
    s_lshl_b32 s6, s4, 10
    s_add_u32 s56, s57, s6
    s_and_b32 s6, s47, 1
    s_lshl_b32 s6, s6, 9
    s_add_u32 s56, s56, s6
    s_lshl_b32 s6, s7, 7
    s_add_u32 s56, s56, s6
    s_mov_b32 s68, 0
    s_mov_b32 s69, -1
    s_mov_b32 s38, 0x07060302
    s_lshl_b32 s6, s3, 3
    s_add_u32 s6, s6, 161280
    v_lshrrev_b32 v86, 1, v85
    v_lshl_add_u32 v86, v86, 2, s6
    v_mov_b32 v87, 161344
    v_and_b32 v88, 1, v85
    v_cmp_eq_u32 vcc, 1, v88
    s_nop 1
    v_cndmask_b32 v9, v87, v86, vcc
    s_setprio 3
    s_lshr_b32 s5, s47, 1
    s_lshl_b32 s6, s5, 5
    s_add_u32 s6, s6, 162880
    s_mul_i32 s5, s5, 288
    s_add_u32 s5, s5, 158976
    v_bfe_u32 v104, v1, 2, 4
    v_mov_b32 v10, s6
    v_mov_b32 v102, s5
    v_cmp_eq_u32 vcc, 0, v104
    v_add_u32 v103, 2432, v102
    v_lshrrev_b32 v105, 6, v1
    v_cndmask_b32 v10, v10, v102, vcc
    v_cmp_eq_u32 vcc, 1, v104
    s_nop 1
    v_cndmask_b32 v10, v10, v103, vcc
    v_lshl_add_u32 v10, v105, 4, v10
    s_and_b32 s5, s3, 3
    s_lshl_b32 s5, s5, 1
    s_add_u32 s5, s5, 0
    v_bfe_u32 v102, v1, 4, 2
    v_bfe_u32 v103, v1, 2, 2
    v_lshrrev_b32 v104, 6, v1
    v_bfe_u32 v105, v104, 0, 1
    v_lshl_or_b32 v105, v105, 2, v102
    v_xor_b32 v105, s5, v105
    v_lshlrev_b32 v105, 5, v105
    v_lshl_add_u32 v105, v103, 3, v105
    v_lshl_add_u32 v104, v104, 3, v102
    v_lshl_add_u32 v106, v104, 8, v105
    v_add_u32 v106, 118784, v106
    v_bfe_u32 v102, v1, 4, 2
    v_bfe_u32 v103, v1, 2, 2
    v_lshrrev_b32 v104, 6, v1
    v_bfe_u32 v105, v104, 1, 1
    v_lshl_or_b32 v105, v105, 2, v102
    v_xor_b32 v105, s5, v105
    v_lshlrev_b32 v105, 5, v105
    v_lshl_add_u32 v105, v103, 3, v105
    v_lshl_add_u32 v104, v104, 2, v102
    v_lshl_add_u32 v107, v104, 8, v105
    v_add_u32 v107, 151552, v107
    s_and_b32 s5, s3, 3
    s_lshl_b32 s5, s5, 1
    s_add_u32 s5, s5, 1
    v_bfe_u32 v102, v1, 4, 2
    v_bfe_u32 v103, v1, 2, 2
    v_lshrrev_b32 v104, 6, v1
    v_bfe_u32 v105, v104, 0, 1
    v_lshl_or_b32 v105, v105, 2, v102
    v_xor_b32 v105, s5, v105
    v_lshlrev_b32 v105, 5, v105
    v_lshl_add_u32 v105, v103, 3, v105
    v_lshl_add_u32 v104, v104, 3, v102
    v_lshl_add_u32 v108, v104, 8, v105
    v_add_u32 v108, 118784, v108
    v_bfe_u32 v102, v1, 4, 2
    v_bfe_u32 v103, v1, 2, 2
    v_lshrrev_b32 v104, 6, v1
    v_bfe_u32 v105, v104, 1, 1
    v_lshl_or_b32 v105, v105, 2, v102
    v_xor_b32 v105, s5, v105
    v_lshlrev_b32 v105, 5, v105
    v_lshl_add_u32 v105, v103, 3, v105
    v_lshl_add_u32 v104, v104, 2, v102
    v_lshl_add_u32 v109, v104, 8, v105
    v_add_u32 v109, 151552, v109
    s_cmp_eq_u32 s3, 3
    s_cbranch_scc1 L_clr
    s_waitcnt vmcnt(1)
    s_branch L_cdone
L_clr:
    v_mov_b32 v90, -1
    v_mov_b32 v91, -1
    v_mov_b32 v92, -1
    v_mov_b32 v93, -1
    s_mul_i32 s6, s2, 3328
    s_add_u32 s6, s6, 1048576
    v_lshlrev_b32 v101, 2, v1
    buffer_store_dwordx4 v[90:93], v101, s[24:27], s6 offen sc1
    buffer_store_dwordx4 v[90:93], v101, s[24:27], s6 offen offset:1024 sc1
    buffer_store_dwordx4 v[90:93], v101, s[24:27], s6 offen offset:2048 sc1
    s_mov_b64 exec, 0xffff
    buffer_store_dwordx4 v[90:93], v101, s[24:27], s6 offen offset:3072 sc1
    s_mov_b64 exec, -1
    s_waitcnt vmcnt(5)
L_cdone:
    v_readfirstlane_b32 s41, v96
    v_lshlrev_b32 v86, 16, v94
    v_and_b32 v87, 0xffff0000, v94
    v_mov_b32 v88, 0
    v_lshl_add_u32 v89, v2, 1, s74
    v_add_u32 v90, s74, v2
    ds_write_b64 v89, v[86:87] offset:0
    ds_write_b32 v90, v94 offset:3328
    ds_write_b32 v90, v88 offset:5760
    v_mul_f32 v93, v86, v86
    v_add_f32 v92, v86, v87
    v_fmac_f32 v93, v87, v87
    s_nop 1
    v_permlane32_swap_b32 v92, v93
    v_add_f32 v92, v92, v93
    s_nop 1
    v_add_f32_dpp v92, v92, v92 row_ror:8 row_mask:0xf bank_mask:0xf
    s_nop 1
    v_add_f32_dpp v92, v92, v92 row_ror:4 row_mask:0xf bank_mask:0xf
    s_nop 1
    v_add_f32_dpp v92, v92, v92 row_ror:2 row_mask:0xf bank_mask:0xf
    s_nop 1
    v_add_f32_dpp v92, v92, v92 row_ror:1 row_mask:0xf bank_mask:0xf
    s_nop 1
    v_add_f32_dpp v92, v92, v92 row_bcast:15 row_mask:0xa bank_mask:0xf
    ds_write_b32 v9, v92
    s_mul_i32 s41, s41, 0x9e3779b1
    s_add_u32 s41, s41, 0x7f4a7c15
    s_and_b32 s41, s41, 0x1fffffff
    s_and_b32 s40, s41, 0xfff
    s_cmp_lg_u32 s3, 0
    s_cbranch_scc1 L_noextra
    v_lshlrev_b32 v100, 2, v100
    v_add_u32 v100, 1024, v100
    v_lshlrev_b32 v86, 16, v95
    v_and_b32 v87, 0xffff0000, v95
    v_mov_b32 v88, 0
    v_lshl_add_u32 v89, v100, 1, s74
    v_add_u32 v90, s74, v100
    ds_write_b64 v89, v[86:87] offset:0
    ds_write_b32 v90, v95 offset:3328
    ds_write_b32 v90, v88 offset:5760
    v_cndmask_b32 v86, v86, v88, s[68:69]
    v_cndmask_b32 v87, v87, v88, s[68:69]
    v_add_u32 v100, 32, v9
    v_min_u32 v100, 161344, v100
    v_mul_f32 v93, v86, v86
    v_add_f32 v92, v86, v87
    v_fmac_f32 v93, v87, v87
    s_nop 1
    v_permlane32_swap_b32 v92, v93
    v_add_f32 v92, v92, v93
    s_nop 1
    v_add_f32_dpp v92, v92, v92 row_ror:8 row_mask:0xf bank_mask:0xf
    s_nop 1
    v_add_f32_dpp v92, v92, v92 row_ror:4 row_mask:0xf bank_mask:0xf
    s_nop 1
    v_add_f32_dpp v92, v92, v92 row_ror:2 row_mask:0xf bank_mask:0xf
    s_nop 1
    v_add_f32_dpp v92, v92, v92 row_ror:1 row_mask:0xf bank_mask:0xf
    s_nop 1
    v_add_f32_dpp v92, v92, v92 row_bcast:15 row_mask:0xa bank_mask:0xf
    ds_write_b32 v100, v92
    v_mov_b32 v86, s40
    v_mov_b32 v87, 163696
    ds_write_b32 v87, v86
L_noextra:
    s_waitcnt lgkmcnt(0)
    s_barrier
    ds_read_b64_tr_b16 a[64:65], v106 offset:0
    ds_read_b64_tr_b16 a[66:67], v106 offset:1024
    ds_read_b64_tr_b16 a[68:69], v106 offset:8192
    ds_read_b64_tr_b16 a[70:71], v106 offset:9216
    ds_read_b64_tr_b16 a[72:73], v106 offset:16384
    ds_read_b64_tr_b16 a[74:75], v106 offset:17408
    ds_read_b64_tr_b16 a[76:77], v106 offset:24576
    ds_read_b64_tr_b16 a[78:79], v106 offset:25600
    ds_read_b64_tr_b16 a[96:97], v107
    ds_read_b64_tr_b16 a[80:81], v108 offset:0
    ds_read_b64_tr_b16 a[82:83], v108 offset:1024
    ds_read_b64_tr_b16 a[84:85], v108 offset:8192
    ds_read_b64_tr_b16 a[86:87], v108 offset:9216
    ds_read_b64_tr_b16 a[88:89], v108 offset:16384
    ds_read_b64_tr_b16 a[90:91], v108 offset:17408
    ds_read_b64_tr_b16 a[92:93], v108 offset:24576
    ds_read_b64_tr_b16 a[94:95], v108 offset:25600
    ds_read_b64_tr_b16 a[98:99], v109
    s_cmp_lg_u32 s3, 3
    s_cbranch_scc1 L_noarr
    s_lshl_b32 s6, s75, 29
    s_or_b32 s6, s6, s41
    v_mov_b32 v90, s6
    s_lshl_b32 s6, s44, 7
    s_lshr_b32 s7, s2, 3
    s_lshl_b32 s7, s7, 2
    s_add_u32 s6, s6, s7
    s_add_u32 s6, s6, 524288
    v_mov_b32 v91, s6
    s_waitcnt vmcnt(0)
    s_mov_b64 exec, 1
    buffer_store_dword v90, v91, s[24:27], 0 offen sc1
    s_mov_b64 exec, -1
L_noarr:
    s_waitcnt lgkmcnt(0)
    v_mov_b32 v126, 1
    ds_write_b32 v7, v126 offset:16
    v_lshrrev_b32 v126, 6, v1
    v_lshlrev_b32 v126, 3, v126
    v_sub_u32 v126, v10, v126
    v_mov_b32 v127, s74
    ds_read_b128 v[82:85], v10 offset:0
    ds_read_b128 v[86:89], v10 offset:64
    ds_read_b128 v[90:93], v10 offset:128
    ds_read_b128 v[94:97], v10 offset:192
    ds_read_b64 v[98:99], v126 offset:256
    ds_read_b128 v[102:105], v127 offset:5632
    ds_read_b128 v[106:109], v127 offset:5648
    ds_read_b128 v[110:113], v127 offset:5664
    s_waitcnt lgkmcnt(7)
    v_mfma_f32_16x16x32_bf16 v[118:121], v[82:85], a[64:67], 0
    v_mfma_f32_16x16x32_bf16 v[122:125], v[82:85], a[80:83], 0
    s_waitcnt lgkmcnt(6)
    v_mfma_f32_16x16x32_bf16 v[118:121], v[86:89], a[68:71], v[118:121]
    v_mfma_f32_16x16x32_bf16 v[122:125], v[86:89], a[84:87], v[122:125]
    s_waitcnt lgkmcnt(5)
    v_mfma_f32_16x16x32_bf16 v[118:121], v[90:93], a[72:75], v[118:121]
    v_mfma_f32_16x16x32_bf16 v[122:125], v[90:93], a[88:91], v[122:125]
    s_waitcnt lgkmcnt(4)
    v_mfma_f32_16x16x32_bf16 v[118:121], v[94:97], a[76:79], v[118:121]
    v_mfma_f32_16x16x32_bf16 v[122:125], v[94:97], a[92:95], v[122:125]
    s_waitcnt lgkmcnt(3)
    v_mfma_f32_16x16x16_bf16 v[118:121], v[98:99], a[96:97], v[118:121]
    v_mfma_f32_16x16x16_bf16 v[122:125], v[98:99], a[98:99], v[122:125]
    s_waitcnt lgkmcnt(0)
    v_pk_add_f32 v[102:103], v[102:103], v[104:105]
    v_pk_add_f32 v[106:107], v[106:107], v[108:109]
    v_pk_add_f32 v[102:103], v[102:103], v[110:111]
    v_pk_add_f32 v[102:103], v[102:103], v[106:107]
    v_mul_f32 v102, 0x3ae38e39, v102
    v_mul_f32 v103, 0x3ae38e39, v103
    v_fma_f32 v103, -v102, v102, v103
    v_max_f32 v103, 0, v103
    v_add_f32 v104, 0x3727c5ac, v103
    v_rsq_f32 v104, v104
    v_add_f32 v118, v118, v119
    v_fma_f32 v118, -v102, v120, v118
    v_add_f32 v122, v122, v123
    v_fma_f32 v122, -v102, v124, v122
    v_mul_f32 v104, 0x3e0293ee, v104
    s_mov_b64 exec, 0xffff
    v_mul_f32 v118, v118, v104
    v_mul_f32 v122, v122, v104
    v_and_b32 v118, 0xfffff000, v118
    v_and_b32 v122, 0xfffff000, v122
    v_or_b32 v118, s40, v118
    v_or_b32 v122, s40, v122
    buffer_store_dword v118, v1, s[24:27], s56 offen
    buffer_store_dword v122, v1, s[24:27], s56 offen offset:64
    s_mov_b64 exec, -1
    v_add_u32 v100, 4096, v2
    v_lshlrev_b32 v101, 1, v0
    v_add_u32 v101, 8192, v101
    global_load_dword v102, v2, s[30:31] offset:0
    global_load_dword v103, v2, s[30:31] offset:2048
    global_load_dword v104, v100, s[30:31] offset:0
    global_load_dword v105, v100, s[30:31] offset:2048
    global_load_ushort v106, v101, s[30:31]
    global_load_dword v107, v2, s[32:33] offset:0
    global_load_dword v108, v2, s[32:33] offset:2048
    global_load_dword v109, v100, s[32:33] offset:0
    global_load_dword v110, v100, s[32:33] offset:2048
    global_load_ushort v111, v101, s[32:33]
    global_load_dword v112, v2, s[34:35] offset:0
    global_load_dword v113, v2, s[34:35] offset:2048
    global_load_dword v114, v100, s[34:35] offset:0
    global_load_dword v115, v100, s[34:35] offset:2048
    global_load_ushort v116, v101, s[34:35]
    v_lshrrev_b32 v83, 2, v1
    s_and_b32 s7, s3, 3
    v_and_b32 v84, 15, v83
    v_lshrrev_b32 v85, 4, v83
    v_and_b32 v88, 1, v85
    s_lshl_b32 s50, s44, 4
    s_add_u32 s50, s50, s49
    s_mul_i32 s6, s50, 5
    s_lshl_b32 s76, s50, 2
    s_add_u32 s76, s76, 64
    s_cmp_lt_u32 s50, 64
    s_cselect_b32 s51, s6, s76
    s_cselect_b32 s52, 5, 4
    s_lshl_b32 s5, s45, 3
    s_add_u32 s5, s5, s44
    s_lshl_b32 s6, s5, 13
    s_add_u32 s6, s6, 1048576
    s_lshl_b32 s60, s7, 11
    s_add_u32 s60, s60, s6
    s_lshl_b32 s58, s49, 8
    s_add_u32 s6, s6, s58
    s_lshl_b32 s58, s46, 11
    s_add_u32 s6, s6, s58
    s_lshl_b32 s58, s7, 6
    s_add_u32 s58, s58, s6
    s_lshl_b32 s6, s5, 7
    s_add_u32 s6, s6, 1441792
    s_lshl_b32 s61, s7, 5
    s_add_u32 s61, s61, s6
    s_lshl_b32 s59, s46, 6
    s_add_u32 s6, s6, s59
    s_lshl_b32 s59, s47, 2
    s_add_u32 s59, s59, s6
    s_mul_i32 s63, s5, 16384
    s_add_u32 s63, s63, 1179648
    s_add_u32 s64, s63, 4096
    s_and_b32 s6, s49, 7
    s_lshl_b32 s6, s6, 5
    s_lshr_b32 s76, s49, 3
    s_lshl_b32 s76, s76, 9
    s_add_u32 s6, s6, s76
    s_lshl_b32 s76, s7, 8
    s_add_u32 s6, s6, s76
    s_add_u32 s6, s6, 512
    s_lshl_b32 s76, s49, 6
    s_lshl_b32 s62, s7, 5
    s_add_u32 s76, s76, s62
    s_bitcmp1_b32 s7, 1
    s_cselect_b32 s6, s6, s76
    s_mul_i32 s76, s45, 131072
    s_add_u32 s6, s6, s76
    s_mul_i32 s62, s44, 2048
    s_add_u32 s6, s6, s62
    s_add_u32 s62, s6, 1179648
    s_mul_i32 s65, s5, 2560
    s_add_u32 s65, s65, 1843200
    s_mul_i32 s6, s45, 20480
    s_lshl_b32 s66, s51, 2
    s_add_u32 s66, s66, s6
    s_add_u32 s66, s66, 1843200
    s_mov_b32 s70, 0x10f
    s_mov_b32 s71, 0x10f0
    s_mov_b32 s72, 0x70c00
    s_mov_b32 s73, 0x70c000
    v_bfe_u32 v86, v83, 3, 2
    v_and_b32 v87, 3, v83
    v_lshl_add_u32 v86, v86, 2, v87
    v_subrev_u32 v87, 6, v86
    v_min_u32 v86, v86, v87
    v_min_u32 v86, 4, v86
    s_lshl_b32 s6, s51, 2
    s_add_u32 s6, s6, 155648
    v_lshl_add_u32 v8, v86, 2, s6
    v_lshrrev_b32 v89, 1, v85
    v_lshl_add_u32 v89, v89, 4, v84
    v_lshlrev_b32 v89, 1, v89
    v_lshlrev_b32 v6, 5, v88
    v_add_u32 v6, 161216, v6
    v_bfe_u32 v86, v84, 2, 1
    v_mul_u32_u24 v86, 576, v86
    v_lshl_add_u32 v4, v85, 4, v86
    v_add_u32 v4, 155648, v4
    s_lshl_b32 s6, s3, 7
    s_add_u32 s6, s6, 160128
    v_mul_u32_u24 v3, 576, v88
    v_add3_u32 v3, v3, v89, s6
    v_lshl_add_u32 v5, v88, 11, v89
    s_mov_b32 s78, s57
    s_mov_b32 s76, 0
    s_mov_b32 s77, 6
    s_mov_b32 s79, 0
    s_waitcnt vmcnt(0)
    buffer_load_dword v90, v2, s[24:27], s78 offen offset:0 sc1
    buffer_load_dword v91, v2, s[24:27], s78 offen offset:1024 sc1
    buffer_load_dword v92, v2, s[24:27], s78 offen offset:2048 sc1
    buffer_load_dword v93, v2, s[24:27], s78 offen offset:3072 sc1
    v_lshlrev_b32 v82, 16, v102
    v_lshlrev_b32 v83, 16, v107
    v_lshlrev_b32 v84, 16, v112
    v_mul_f32 v85, v82, v82
    v_mul_f32 v85, 0xbdd2d3e8, v85
    v_mul_f32 v86, v85, v82
    v_mul_f32 v87, v85, v83
    v_mul_f32 v87, 0x40400000, v87
    v_and_b32 v89, 0xffff0000, v86
    v_sub_f32 v10, v86, v89
    v_cvt_pk_bf16_f32 v10, v89, v10
    v_and_b32 v89, 0xffff0000, v87
    v_sub_f32 v11, v87, v89
    v_cvt_pk_bf16_f32 v11, v89, v11
    v_perm_b32 v12, v87, v86, s38
    v_mul_f32 v85, v83, v83
    v_mul_f32 v85, 0xbdd2d3e8, v85
    v_add_f32 v86, 0xc0135761, v85
    v_mul_f32 v87, v86, v83
    v_fmac_f32 v86, 2.0, v85
    v_mul_f32 v86, v86, v82
    v_and_b32 v89, 0xffff0000, v86
    v_sub_f32 v13, v86, v89
    v_cvt_pk_bf16_f32 v13, v89, v13
    v_and_b32 v89, 0xffff0000, v87
    v_sub_f32 v14, v87, v89
    v_cvt_pk_bf16_f32 v14, v89, v14
    v_mul_f32 v86, v82, v84
    v_mul_f32 v87, v83, v84
    v_and_b32 v89, 0xffff0000, v86
    v_sub_f32 v15, v86, v89
    v_cvt_pk_bf16_f32 v15, v89, v15
    v_and_b32 v89, 0xffff0000, v87
    v_sub_f32 v16, v87, v89
    v_cvt_pk_bf16_f32 v16, v89, v16
    v_mov_b32 v17, 0
    v_and_b32 v82, 0xffff0000, v102
    v_and_b32 v83, 0xffff0000, v107
    v_and_b32 v84, 0xffff0000, v112
    v_mul_f32 v85, v82, v82
    v_mul_f32 v85, 0xbdd2d3e8, v85
    v_mul_f32 v86, v85, v82
    v_mul_f32 v87, v85, v83
    v_mul_f32 v87, 0x40400000, v87
    v_and_b32 v89, 0xffff0000, v86
    v_sub_f32 v18, v86, v89
    v_cvt_pk_bf16_f32 v18, v89, v18
    v_and_b32 v89, 0xffff0000, v87
    v_sub_f32 v19, v87, v89
    v_cvt_pk_bf16_f32 v19, v89, v19
    v_perm_b32 v20, v87, v86, s38
    v_mul_f32 v85, v83, v83
    v_mul_f32 v85, 0xbdd2d3e8, v85
    v_add_f32 v86, 0xc0135761, v85
    v_mul_f32 v87, v86, v83
    v_fmac_f32 v86, 2.0, v85
    v_mul_f32 v86, v86, v82
    v_and_b32 v89, 0xffff0000, v86
    v_sub_f32 v21, v86, v89
    v_cvt_pk_bf16_f32 v21, v89, v21
    v_and_b32 v89, 0xffff0000, v87
    v_sub_f32 v22, v87, v89
    v_cvt_pk_bf16_f32 v22, v89, v22
    v_mul_f32 v86, v82, v84
    v_mul_f32 v87, v83, v84
    v_and_b32 v89, 0xffff0000, v86
    v_sub_f32 v23, v86, v89
    v_cvt_pk_bf16_f32 v23, v89, v23
    v_and_b32 v89, 0xffff0000, v87
    v_sub_f32 v24, v87, v89
    v_cvt_pk_bf16_f32 v24, v89, v24
    v_mov_b32 v25, 0
    v_lshlrev_b32 v82, 16, v103
    v_lshlrev_b32 v83, 16, v108
    v_lshlrev_b32 v84, 16, v113
    v_mul_f32 v85, v82, v82
    v_mul_f32 v85, 0xbdd2d3e8, v85
    v_mul_f32 v86, v85, v82
    v_mul_f32 v87, v85, v83
    v_mul_f32 v87, 0x40400000, v87
    v_and_b32 v89, 0xffff0000, v86
    v_sub_f32 v26, v86, v89
    v_cvt_pk_bf16_f32 v26, v89, v26
    v_and_b32 v89, 0xffff0000, v87
    v_sub_f32 v27, v87, v89
    v_cvt_pk_bf16_f32 v27, v89, v27
    v_perm_b32 v28, v87, v86, s38
    v_mul_f32 v85, v83, v83
    v_mul_f32 v85, 0xbdd2d3e8, v85
    v_add_f32 v86, 0xc0135761, v85
    v_mul_f32 v87, v86, v83
    v_fmac_f32 v86, 2.0, v85
    v_mul_f32 v86, v86, v82
    v_and_b32 v89, 0xffff0000, v86
    v_sub_f32 v29, v86, v89
    v_cvt_pk_bf16_f32 v29, v89, v29
    v_and_b32 v89, 0xffff0000, v87
    v_sub_f32 v30, v87, v89
    v_cvt_pk_bf16_f32 v30, v89, v30
    v_mul_f32 v86, v82, v84
    v_mul_f32 v87, v83, v84
    v_and_b32 v89, 0xffff0000, v86
    v_sub_f32 v31, v86, v89
    v_cvt_pk_bf16_f32 v31, v89, v31
    v_and_b32 v89, 0xffff0000, v87
    v_sub_f32 v32, v87, v89
    v_cvt_pk_bf16_f32 v32, v89, v32
    v_mov_b32 v33, 0
    v_and_b32 v82, 0xffff0000, v103
    v_and_b32 v83, 0xffff0000, v108
    v_and_b32 v84, 0xffff0000, v113
    v_mul_f32 v85, v82, v82
    v_mul_f32 v85, 0xbdd2d3e8, v85
    v_mul_f32 v86, v85, v82
    v_mul_f32 v87, v85, v83
    v_mul_f32 v87, 0x40400000, v87
    v_and_b32 v89, 0xffff0000, v86
    v_sub_f32 v34, v86, v89
    v_cvt_pk_bf16_f32 v34, v89, v34
    v_and_b32 v89, 0xffff0000, v87
    v_sub_f32 v35, v87, v89
    v_cvt_pk_bf16_f32 v35, v89, v35
    v_perm_b32 v36, v87, v86, s38
    v_mul_f32 v85, v83, v83
    v_mul_f32 v85, 0xbdd2d3e8, v85
    v_add_f32 v86, 0xc0135761, v85
    v_mul_f32 v87, v86, v83
    v_fmac_f32 v86, 2.0, v85
    v_mul_f32 v86, v86, v82
    v_and_b32 v89, 0xffff0000, v86
    v_sub_f32 v37, v86, v89
    v_cvt_pk_bf16_f32 v37, v89, v37
    v_and_b32 v89, 0xffff0000, v87
    v_sub_f32 v38, v87, v89
    v_cvt_pk_bf16_f32 v38, v89, v38
    v_mul_f32 v86, v82, v84
    v_mul_f32 v87, v83, v84
    v_and_b32 v89, 0xffff0000, v86
    v_sub_f32 v39, v86, v89
    v_cvt_pk_bf16_f32 v39, v89, v39
    v_and_b32 v89, 0xffff0000, v87
    v_sub_f32 v40, v87, v89
    v_cvt_pk_bf16_f32 v40, v89, v40
    v_mov_b32 v41, 0
    v_lshlrev_b32 v82, 16, v104
    v_lshlrev_b32 v83, 16, v109
    v_lshlrev_b32 v84, 16, v114
    v_mul_f32 v85, v82, v82
    v_mul_f32 v85, 0xbdd2d3e8, v85
    v_mul_f32 v86, v85, v82
    v_mul_f32 v87, v85, v83
    v_mul_f32 v87, 0x40400000, v87
    v_and_b32 v89, 0xffff0000, v86
    v_sub_f32 v42, v86, v89
    v_cvt_pk_bf16_f32 v42, v89, v42
    v_and_b32 v89, 0xffff0000, v87
    v_sub_f32 v43, v87, v89
    v_cvt_pk_bf16_f32 v43, v89, v43
    v_perm_b32 v44, v87, v86, s38
    v_mul_f32 v85, v83, v83
    v_mul_f32 v85, 0xbdd2d3e8, v85
    v_add_f32 v86, 0xc0135761, v85
    v_mul_f32 v87, v86, v83
    v_fmac_f32 v86, 2.0, v85
    v_mul_f32 v86, v86, v82
    v_and_b32 v89, 0xffff0000, v86
    v_sub_f32 v45, v86, v89
    v_cvt_pk_bf16_f32 v45, v89, v45
    v_and_b32 v89, 0xffff0000, v87
    v_sub_f32 v46, v87, v89
    v_cvt_pk_bf16_f32 v46, v89, v46
    v_mul_f32 v86, v82, v84
    v_mul_f32 v87, v83, v84
    v_and_b32 v89, 0xffff0000, v86
    v_sub_f32 v47, v86, v89
    v_cvt_pk_bf16_f32 v47, v89, v47
    v_and_b32 v89, 0xffff0000, v87
    v_sub_f32 v48, v87, v89
    v_cvt_pk_bf16_f32 v48, v89, v48
    v_mov_b32 v49, 0
    v_and_b32 v82, 0xffff0000, v104
    v_and_b32 v83, 0xffff0000, v109
    v_and_b32 v84, 0xffff0000, v114
    v_mul_f32 v85, v82, v82
    v_mul_f32 v85, 0xbdd2d3e8, v85
    v_mul_f32 v86, v85, v82
    v_mul_f32 v87, v85, v83
    v_mul_f32 v87, 0x40400000, v87
    v_and_b32 v89, 0xffff0000, v86
    v_sub_f32 v50, v86, v89
    v_cvt_pk_bf16_f32 v50, v89, v50
    v_and_b32 v89, 0xffff0000, v87
    v_sub_f32 v51, v87, v89
    v_cvt_pk_bf16_f32 v51, v89, v51
    v_perm_b32 v52, v87, v86, s38
    v_mul_f32 v85, v83, v83
    v_mul_f32 v85, 0xbdd2d3e8, v85
    v_add_f32 v86, 0xc0135761, v85
    v_mul_f32 v87, v86, v83
    v_fmac_f32 v86, 2.0, v85
    v_mul_f32 v86, v86, v82
    v_and_b32 v89, 0xffff0000, v86
    v_sub_f32 v53, v86, v89
    v_cvt_pk_bf16_f32 v53, v89, v53
    v_and_b32 v89, 0xffff0000, v87
    v_sub_f32 v54, v87, v89
    v_cvt_pk_bf16_f32 v54, v89, v54
    v_mul_f32 v86, v82, v84
    v_mul_f32 v87, v83, v84
    v_and_b32 v89, 0xffff0000, v86
    v_sub_f32 v55, v86, v89
    v_cvt_pk_bf16_f32 v55, v89, v55
    v_and_b32 v89, 0xffff0000, v87
    v_sub_f32 v56, v87, v89
    v_cvt_pk_bf16_f32 v56, v89, v56
    v_mov_b32 v57, 0
    v_lshlrev_b32 v82, 16, v105
    v_lshlrev_b32 v83, 16, v110
    v_lshlrev_b32 v84, 16, v115
    v_mul_f32 v85, v82, v82
    v_mul_f32 v85, 0xbdd2d3e8, v85
    v_mul_f32 v86, v85, v82
    v_mul_f32 v87, v85, v83
    v_mul_f32 v87, 0x40400000, v87
    v_and_b32 v89, 0xffff0000, v86
    v_sub_f32 v58, v86, v89
    v_cvt_pk_bf16_f32 v58, v89, v58
    v_and_b32 v89, 0xffff0000, v87
    v_sub_f32 v59, v87, v89
    v_cvt_pk_bf16_f32 v59, v89, v59
    v_perm_b32 v60, v87, v86, s38
    v_mul_f32 v85, v83, v83
    v_mul_f32 v85, 0xbdd2d3e8, v85
    v_add_f32 v86, 0xc0135761, v85
    v_mul_f32 v87, v86, v83
    v_fmac_f32 v86, 2.0, v85
    v_mul_f32 v86, v86, v82
    v_and_b32 v89, 0xffff0000, v86
    v_sub_f32 v61, v86, v89
    v_cvt_pk_bf16_f32 v61, v89, v61
    v_and_b32 v89, 0xffff0000, v87
    v_sub_f32 v62, v87, v89
    v_cvt_pk_bf16_f32 v62, v89, v62
    v_mul_f32 v86, v82, v84
    v_mul_f32 v87, v83, v84
    v_and_b32 v89, 0xffff0000, v86
    v_sub_f32 v63, v86, v89
    v_cvt_pk_bf16_f32 v63, v89, v63
    v_and_b32 v89, 0xffff0000, v87
    v_sub_f32 v64, v87, v89
    v_cvt_pk_bf16_f32 v64, v89, v64
    v_mov_b32 v65, 0
    v_and_b32 v82, 0xffff0000, v105
    v_and_b32 v83, 0xffff0000, v110
    v_and_b32 v84, 0xffff0000, v115
    v_mul_f32 v85, v82, v82
    v_mul_f32 v85, 0xbdd2d3e8, v85
    v_mul_f32 v86, v85, v82
    v_mul_f32 v87, v85, v83
    v_mul_f32 v87, 0x40400000, v87
    v_and_b32 v89, 0xffff0000, v86
    v_sub_f32 v66, v86, v89
    v_cvt_pk_bf16_f32 v66, v89, v66
    v_and_b32 v89, 0xffff0000, v87
    v_sub_f32 v67, v87, v89
    v_cvt_pk_bf16_f32 v67, v89, v67
    v_perm_b32 v68, v87, v86, s38
    v_mul_f32 v85, v83, v83
    v_mul_f32 v85, 0xbdd2d3e8, v85
    v_add_f32 v86, 0xc0135761, v85
    v_mul_f32 v87, v86, v83
    v_fmac_f32 v86, 2.0, v85
    v_mul_f32 v86, v86, v82
    v_and_b32 v89, 0xffff0000, v86
    v_sub_f32 v69, v86, v89
    v_cvt_pk_bf16_f32 v69, v89, v69
    v_and_b32 v89, 0xffff0000, v87
    v_sub_f32 v70, v87, v89
    v_cvt_pk_bf16_f32 v70, v89, v70
    v_mul_f32 v86, v82, v84
    v_mul_f32 v87, v83, v84
    v_and_b32 v89, 0xffff0000, v86
    v_sub_f32 v71, v86, v89
    v_cvt_pk_bf16_f32 v71, v89, v71
    v_and_b32 v89, 0xffff0000, v87
    v_sub_f32 v72, v87, v89
    v_cvt_pk_bf16_f32 v72, v89, v72
    v_mov_b32 v73, 0
    v_lshlrev_b32 v82, 16, v106
    v_lshlrev_b32 v83, 16, v111
    v_lshlrev_b32 v84, 16, v116
    v_mul_f32 v85, v82, v82
    v_mul_f32 v85, 0xbdd2d3e8, v85
    v_mul_f32 v86, v85, v82
    v_mul_f32 v87, v85, v83
    v_mul_f32 v87, 0x40400000, v87
    v_and_b32 v89, 0xffff0000, v86
    v_sub_f32 v74, v86, v89
    v_cvt_pk_bf16_f32 v74, v89, v74
    v_and_b32 v89, 0xffff0000, v87
    v_sub_f32 v75, v87, v89
    v_cvt_pk_bf16_f32 v75, v89, v75
    v_perm_b32 v76, v87, v86, s38
    v_mul_f32 v85, v83, v83
    v_mul_f32 v85, 0xbdd2d3e8, v85
    v_add_f32 v86, 0xc0135761, v85
    v_mul_f32 v87, v86, v83
    v_fmac_f32 v86, 2.0, v85
    v_mul_f32 v86, v86, v82
    v_and_b32 v89, 0xffff0000, v86
    v_sub_f32 v77, v86, v89
    v_cvt_pk_bf16_f32 v77, v89, v77
    v_and_b32 v89, 0xffff0000, v87
    v_sub_f32 v78, v87, v89
    v_cvt_pk_bf16_f32 v78, v89, v78
    v_mul_f32 v86, v82, v84
    v_mul_f32 v87, v83, v84
    v_and_b32 v89, 0xffff0000, v86
    v_sub_f32 v79, v86, v89
    v_cvt_pk_bf16_f32 v79, v89, v79
    v_and_b32 v89, 0xffff0000, v87
    v_sub_f32 v80, v87, v89
    v_cvt_pk_bf16_f32 v80, v89, v80
    v_mov_b32 v81, 0
    v_bfe_u32 v88, v1, 2, 2
    v_lshrrev_b32 v89, 6, v1
    v_lshlrev_b32 v89, 4, v89
    v_add_u32 v89, 163328, v89
    v_cmp_eq_u32 vcc, 0, v88
    v_add_u32 v87, 4480, v4
    s_nop 0
    v_cndmask_b32 v118, v89, v87, vcc
    v_cmp_eq_u32 vcc, 1, v88
    v_add_u32 v87, 4608, v4
    s_nop 0
    v_cndmask_b32 v119, v89, v87, vcc
    v_cmp_eq_u32 vcc, 2, v88
    v_add_u32 v87, 4736, v4
    s_nop 0
    v_cndmask_b32 v120, v89, v87, vcc
    v_cmp_eq_u32 vcc, 3, v88
    v_add_u32 v87, 4864, v4
    s_nop 0
    v_cndmask_b32 v121, v89, v87, vcc
    v_lshrrev_b32 v117, 7, v0
    v_mul_u32_u24 v117, 320, v117
    v_lshl_add_u32 v117, v0, 1, v117
    v_add_u32 v117, 157952, v117
    s_waitcnt vmcnt(0)
    s_branch L_ga_w
L_attn:
    s_mov_b32 s78, s57
    s_mov_b32 s76, 1
    s_mov_b32 s77, -1
    s_cmp_lg_u32 s54, 0
    s_cbranch_scc1 L_ga0
    s_add_u32 s78, s78, 262144
L_ga0:
    v_bfe_u32 v88, v1, 2, 2
    v_lshrrev_b32 v89, 6, v1
    v_lshlrev_b32 v89, 4, v89
    v_add_u32 v89, 163328, v89
    v_cmp_eq_u32 vcc, 0, v88
    v_add_u32 v87, 4480, v4
    s_nop 0
    v_cndmask_b32 v118, v89, v87, vcc
    v_cmp_eq_u32 vcc, 1, v88
    v_add_u32 v87, 4608, v4
    s_nop 0
    v_cndmask_b32 v119, v89, v87, vcc
    v_cmp_eq_u32 vcc, 2, v88
    v_add_u32 v87, 4736, v4
    s_nop 0
    v_cndmask_b32 v120, v89, v87, vcc
    v_cmp_eq_u32 vcc, 3, v88
    v_add_u32 v87, 4864, v4
    s_nop 0
    v_cndmask_b32 v121, v89, v87, vcc
    v_lshrrev_b32 v117, 7, v0
    v_mul_u32_u24 v117, 320, v117
    v_lshl_add_u32 v117, v0, 1, v117
    v_add_u32 v117, 157952, v117
L_ga:
    buffer_load_dword v90, v2, s[24:27], s78 offen offset:0 sc1
    buffer_load_dword v91, v2, s[24:27], s78 offen offset:1024 sc1
    buffer_load_dword v92, v2, s[24:27], s78 offen offset:2048 sc1
    buffer_load_dword v93, v2, s[24:27], s78 offen offset:3072 sc1
    s_waitcnt vmcnt(0)
L_ga_w:
    v_xor_b32 v90, s40, v90
    v_xor_b32 v91, s40, v91
    v_xor_b32 v92, s40, v92
    v_xor_b32 v93, s40, v93
    v_or3_b32 v86, v90, v91, v92
    v_or_b32 v86, v86, v93
    v_and_b32 v86, 0xfff, v86
    v_add_f32 v82, v90, v91
    v_add_f32 v84, v92, v93
    v_cmp_ne_u32 vcc, 0, v86
    v_add_f32 v82, v82, v84
    s_cbranch_vccnz L_ga_f
    v_cvt_pk_bf16_f32 v82, v82, v82
    ds_write_b16 v117, v82
    s_waitcnt lgkmcnt(0)
    s_cmp_lg_u32 s53, 0
    s_cbranch_scc1 L_qbar
    v_mov_b32 v126, 1
    ds_write_b32 v7, v126 offset:32
    s_cmp_lg_u32 s76, 0
    s_cbranch_scc1 L_kdone
    v_mov_b32 v127, 163456
L_wf_7:
    ds_read_b128 v[122:125], v127 offset:48
    s_waitcnt lgkmcnt(0)
    v_and_b32 v122, v122, v123
    v_and_b32 v124, v124, v125
    v_and_b32 v122, v122, v124
    v_cmp_ne_u32 vcc, 0, v122
    s_cbranch_vccnz L_wf_7_d
    s_sub_u32 s55, s55, 1
    s_cbranch_scc1 L_end
    s_sleep 1
    s_branch L_wf_7
L_wf_7_d:
    s_mov_b32 s76, 2
L_kread:
    v_bfe_u32 v90, v1, 2, 4
    v_lshrrev_b32 v91, 6, v1
    s_lshl_b32 s6, s3, 14
    v_lshl_add_u32 v92, v90, 8, s6
    v_add_u32 v93, 0, v91
    v_xor_b32 v93, v93, v90
    v_lshl_add_u32 v94, v93, 4, v92
    ds_read_b128 a[0:3], v94 offset:0
    ds_read_b128 a[16:19], v94 offset:4096
    ds_read_b128 a[32:35], v94 offset:8192
    ds_read_b128 a[48:51], v94 offset:12288
    v_add_u32 v93, 4, v91
    v_xor_b32 v93, v93, v90
    v_lshl_add_u32 v95, v93, 4, v92
    ds_read_b128 a[4:7], v95 offset:0
    ds_read_b128 a[20:23], v95 offset:4096
    ds_read_b128 a[36:39], v95 offset:8192
    ds_read_b128 a[52:55], v95 offset:12288
    v_add_u32 v93, 8, v91
    v_xor_b32 v93, v93, v90
    v_lshl_add_u32 v96, v93, 4, v92
    ds_read_b128 a[8:11], v96 offset:0
    ds_read_b128 a[24:27], v96 offset:4096
    ds_read_b128 a[40:43], v96 offset:8192
    ds_read_b128 a[56:59], v96 offset:12288
    v_add_u32 v93, 12, v91
    v_xor_b32 v93, v93, v90
    v_lshl_add_u32 v97, v93, 4, v92
    ds_read_b128 a[12:15], v97 offset:0
    ds_read_b128 a[28:31], v97 offset:4096
    ds_read_b128 a[44:47], v97 offset:8192
    ds_read_b128 a[60:63], v97 offset:12288
    s_waitcnt lgkmcnt(0)
    v_mov_b32 v126, 1
    ds_write_b32 v7, v126 offset:64
    s_cmp_eq_u32 s76, 1
    s_cbranch_scc1 L_ga
L_kdone:
    s_mov_b32 s77, 48
    v_mov_b32 v127, 163456
L_fq:
    ds_read_b128 v[122:125], v127 offset:32
    s_waitcnt lgkmcnt(0)
    v_and_b32 v122, v122, v123
    v_and_b32 v124, v124, v125
    v_and_b32 v122, v122, v124
    v_cmp_ne_u32 vcc, 0, v122
    s_cbranch_vccnz L_qk
    s_sub_u32 s55, s55, 1
    s_cbranch_scc1 L_end
    s_sub_u32 s77, s77, 1
    s_cmp_lg_u32 s77, 0
    s_cbranch_scc1 L_fq
    s_add_u32 s7, s56, 262144
    s_mov_b64 exec, 0xffff
    buffer_load_dword v101, v1, s[24:27], s56 offen sc1
    buffer_load_dword v102, v1, s[24:27], s56 offen offset:64 sc1
    s_waitcnt vmcnt(0)
    buffer_store_dword v101, v1, s[24:27], s7 offen sc1
    buffer_store_dword v102, v1, s[24:27], s7 offen offset:64 sc1
    s_mov_b64 exec, -1
    s_branch L_fq
L_ga_f:
    s_sub_u32 s55, s55, 1
    s_cbranch_scc1 L_end
    s_sub_u32 s77, s77, 1
    s_cmp_lg_u32 s77, 0
    s_cbranch_scc1 L_ga_f2
    s_add_u32 s78, s78, 262144
    s_add_u32 s7, s56, 262144
    s_mov_b64 exec, 0xffff
    buffer_load_dword v101, v1, s[24:27], s56 offen sc1
    buffer_load_dword v102, v1, s[24:27], s56 offen offset:64 sc1
    s_waitcnt vmcnt(0)
    buffer_store_dword v101, v1, s[24:27], s7 offen sc1
    buffer_store_dword v102, v1, s[24:27], s7 offen offset:64 sc1
    s_mov_b64 exec, -1
L_ga_f2:
    s_cmp_lg_u32 s76, 0
    s_cbranch_scc1 L_ga
    v_mov_b32 v127, 163456
    ds_read_b128 v[122:125], v127 offset:48
    s_waitcnt lgkmcnt(0)
    v_and_b32 v122, v122, v123
    v_and_b32 v124, v124, v125
    v_and_b32 v122, v122, v124
    v_cmp_ne_u32 vcc, 0, v122
    s_cbranch_vccz L_ga
    s_mov_b32 s76, 1
    s_branch L_kread
L_qbar:
    s_barrier
L_qk:
    ds_read_b128 v[82:85], v4 offset:2304
    ds_read_b128 v[86:89], v4 offset:2368
    ds_read_b128 v[90:93], v4 offset:2432
    ds_read_b128 v[94:97], v4 offset:2496
    s_waitcnt lgkmcnt(3)
    v_mfma_f32_16x16x32_bf16 v[98:101], v[82:85], a[0:3], 0
    v_mfma_f32_16x16x32_bf16 v[102:105], v[82:85], a[16:19], 0
    v_mfma_f32_16x16x32_bf16 v[106:109], v[82:85], a[32:35], 0
    v_mfma_f32_16x16x32_bf16 v[110:113], v[82:85], a[48:51], 0
    s_waitcnt lgkmcnt(2)
    v_mfma_f32_16x16x32_bf16 v[98:101], v[86:89], a[4:7], v[98:101]
    v_mfma_f32_16x16x32_bf16 v[102:105], v[86:89], a[20:23], v[102:105]
    v_mfma_f32_16x16x32_bf16 v[106:109], v[86:89], a[36:39], v[106:109]
    v_mfma_f32_16x16x32_bf16 v[110:113], v[86:89], a[52:55], v[110:113]
    s_waitcnt lgkmcnt(1)
    v_mfma_f32_16x16x32_bf16 v[98:101], v[90:93], a[8:11], v[98:101]
    v_mfma_f32_16x16x32_bf16 v[102:105], v[90:93], a[24:27], v[102:105]
    v_mfma_f32_16x16x32_bf16 v[106:109], v[90:93], a[40:43], v[106:109]
    v_mfma_f32_16x16x32_bf16 v[110:113], v[90:93], a[56:59], v[110:113]
    s_waitcnt lgkmcnt(0)
    v_mfma_f32_16x16x32_bf16 v[98:101], v[94:97], a[12:15], v[98:101]
    v_mfma_f32_16x16x32_bf16 v[102:105], v[94:97], a[28:31], v[102:105]
    v_mfma_f32_16x16x32_bf16 v[106:109], v[94:97], a[44:47], v[106:109]
    v_mfma_f32_16x16x32_bf16 v[110:113], v[94:97], a[60:63], v[110:113]
    s_lshl_b32 s6, s3, 3
    v_add_u32 v82, s6, v6
    s_nop 3
    v_cndmask_b32 v114, v98, v102, s[68:69]
    s_nop 1
    v_cndmask_b32 v115, v106, v110, s[68:69]
    v_max_f32 v116, v114, v115
    s_nop 1
    v_max_f32_dpp v116, v116, v116 row_ror:8 row_mask:0xf bank_mask:0xf
    s_nop 1
    v_max_f32_dpp v116, v116, v116 row_ror:4 row_mask:0xf bank_mask:0xf
    s_nop 1
    v_max_f32_dpp v116, v116, v116 row_ror:2 row_mask:0xf bank_mask:0xf
    s_nop 1
    v_max_f32_dpp v116, v116, v116 row_ror:1 row_mask:0xf bank_mask:0xf
    v_mov_b32 v117, v116
    s_nop 1
    v_permlane32_swap_b32 v116, v117
    v_max_f32 v116, v116, v117
    v_sub_f32 v114, v114, v116
    v_sub_f32 v115, v115, v116
    v_exp_f32 v114, v114
    v_exp_f32 v115, v115
    s_nop 0
    v_cvt_pk_bf16_f32 v114, v114, v115
    v_lshlrev_b32 v115, 16, v114
    v_and_b32 v117, 0xffff0000, v114
    v_add_f32 v117, v117, v115
    ds_write_b16 v3, v114
    ds_write_b16_d16_hi v3, v114 offset:64
    v_add_f32_dpp v117, v117, v117 row_ror:8 row_mask:0xf bank_mask:0xf
    s_nop 1
    v_add_f32_dpp v117, v117, v117 row_ror:4 row_mask:0xf bank_mask:0xf
    s_nop 1
    v_add_f32_dpp v117, v117, v117 row_ror:2 row_mask:0xf bank_mask:0xf
    s_nop 1
    v_add_f32_dpp v117, v117, v117 row_ror:1 row_mask:0xf bank_mask:0xf
    v_mov_b32 v115, v117
    s_nop 1
    v_permlane32_swap_b32 v117, v115
    v_add_f32 v117, v117, v115
    ds_write_b64 v82, v[116:117]
    s_waitcnt lgkmcnt(0)
    s_cmp_lg_u32 s53, 0
    s_cbranch_scc1 L_pbar
    v_mov_b32 v126, 1
    ds_write_b32 v7, v126 offset:80
    s_cmp_lg_u32 s79, 0
    s_cbranch_scc1 L_gchk_n
L_gchk:
    v_lshlrev_b32 v98, 2, v1
    v_add_u32 v98, 524288, v98
    buffer_load_dwordx4 v[94:97], v98, s[24:27], 0 offen sc1
L_gchk_n:
    s_lshl_b32 s6, s3, 1
    s_add_u32 s6, s6, 0
    v_bfe_u32 v82, v1, 4, 2
    v_bfe_u32 v83, v1, 2, 2
    v_lshrrev_b32 v84, 6, v1
    v_bfe_u32 v85, v84, 0, 1
    v_lshl_or_b32 v85, v85, 2, v82
    v_xor_b32 v85, s6, v85
    v_lshlrev_b32 v85, 5, v85
    v_lshl_add_u32 v85, v83, 3, v85
    v_lshl_add_u32 v84, v84, 3, v82
    v_lshl_add_u32 v86, v84, 8, v85
    v_add_u32 v86, 65536, v86
    s_lshl_b32 s6, s3, 1
    s_add_u32 s6, s6, 1
    v_bfe_u32 v82, v1, 4, 2
    v_bfe_u32 v83, v1, 2, 2
    v_lshrrev_b32 v84, 6, v1
    v_bfe_u32 v85, v84, 0, 1
    v_lshl_or_b32 v85, v85, 2, v82
    v_xor_b32 v85, s6, v85
    v_lshlrev_b32 v85, 5, v85
    v_lshl_add_u32 v85, v83, 3, v85
    v_lshl_add_u32 v84, v84, 3, v82
    v_lshl_add_u32 v87, v84, 8, v85
    v_add_u32 v87, 65536, v87
    s_cmp_lg_u32 s79, 0
    s_cbranch_scc1 L_gchk_d
    s_waitcnt vmcnt(0)
    v_xor_b32 v94, s41, v94
    v_xor_b32 v95, s41, v95
    v_xor_b32 v96, s41, v96
    v_xor_b32 v97, s41, v97
    v_or3_b32 v99, v94, v95, v96
    v_or_b32 v99, v99, v97
    v_and_b32 v100, 0x1fffffff, v99
    v_cmp_ne_u32 vcc, 0, v100
    s_cbranch_vccnz L_gchk_f
    s_lshl_b32 s6, s75, 29
    v_xor_b32 v94, s6, v94
    v_xor_b32 v95, s6, v95
    v_xor_b32 v96, s6, v96
    v_xor_b32 v97, s6, v97
    v_or3_b32 v99, v94, v95, v96
    v_or_b32 v99, v99, v97
    v_cmp_ne_u32 vcc, 0, v99
    s_lshl_b32 s6, s44, 3
    s_lshr_b64 vcc, vcc, s6
    s_and_b32 s6, vcc_lo, 0xff
    s_cselect_b32 s54, 0, 1
    v_mov_b32 v94, s54
    v_mov_b32 v95, 163700
    ds_write_b32 v95, v94
    s_mov_b32 s79, 1
L_gchk_d:
    s_cmp_lg_u32 s54, 0
    s_cbranch_scc1 L_nocopy
    s_add_u32 s7, s56, 262144
    s_mov_b64 exec, 0xffff
    buffer_load_dword v101, v1, s[24:27], s56 offen sc1
    buffer_load_dword v102, v1, s[24:27], s56 offen offset:64 sc1
    s_waitcnt vmcnt(0)
    buffer_store_dword v101, v1, s[24:27], s7 offen sc1
    buffer_store_dword v102, v1, s[24:27], s7 offen offset:64 sc1
    s_mov_b64 exec, -1
L_nocopy:
    v_mov_b32 v127, 163456
L_wf_8:
    ds_read_b128 v[122:125], v127 offset:80
    s_waitcnt lgkmcnt(0)
    v_and_b32 v122, v122, v123
    v_and_b32 v124, v124, v125
    v_and_b32 v122, v122, v124
    v_cmp_ne_u32 vcc, 0, v122
    s_cbranch_vccnz L_wf_8_d
    s_sub_u32 s55, s55, 1
    s_cbranch_scc1 L_end
    s_branch L_wf_8
L_wf_8_d:
    v_mov_b32 v127, 163456
L_wf_9:
    ds_read_b128 v[122:125], v127 offset:128
    s_waitcnt lgkmcnt(0)
    v_and_b32 v122, v122, v123
    v_and_b32 v124, v124, v125
    v_and_b32 v122, v122, v124
    v_cmp_ne_u32 vcc, 0, v122
    s_cbranch_vccnz L_wf_9_d
    s_sub_u32 s55, s55, 1
    s_cbranch_scc1 L_end
    s_sleep 1
    s_branch L_wf_9
L_wf_9_d:
    v_mov_b32 v124, v86
    v_mov_b32 v125, v87
    ds_read_b64_tr_b16 a[64:65], v124 offset:0
    ds_read_b64_tr_b16 a[66:67], v124 offset:1024
    ds_read_b64_tr_b16 a[96:97], v125 offset:0
    ds_read_b64_tr_b16 a[98:99], v125 offset:1024
    ds_read_b64_tr_b16 a[68:69], v124 offset:8192
    ds_read_b64_tr_b16 a[70:71], v124 offset:9216
    ds_read_b64_tr_b16 a[100:101], v125 offset:8192
    ds_read_b64_tr_b16 a[102:103], v125 offset:9216
    ds_read_b64_tr_b16 a[72:73], v124 offset:16384
    ds_read_b64_tr_b16 a[74:75], v124 offset:17408
    ds_read_b64_tr_b16 a[104:105], v125 offset:16384
    ds_read_b64_tr_b16 a[106:107], v125 offset:17408
    ds_read_b64_tr_b16 a[76:77], v124 offset:24576
    ds_read_b64_tr_b16 a[78:79], v124 offset:25600
    ds_read_b64_tr_b16 a[108:109], v125 offset:24576
    ds_read_b64_tr_b16 a[110:111], v125 offset:25600
    ds_read_b64_tr_b16 a[80:81], v124 offset:32768
    ds_read_b64_tr_b16 a[82:83], v124 offset:33792
    ds_read_b64_tr_b16 a[112:113], v125 offset:32768
    ds_read_b64_tr_b16 a[114:115], v125 offset:33792
    ds_read_b64_tr_b16 a[84:85], v124 offset:40960
    ds_read_b64_tr_b16 a[86:87], v124 offset:41984
    ds_read_b64_tr_b16 a[116:117], v125 offset:40960
    ds_read_b64_tr_b16 a[118:119], v125 offset:41984
    s_branch L_pv
L_pv0:
    s_barrier
    ds_read_b64_tr_b16 a[88:89], v124 offset:49152
    ds_read_b64_tr_b16 a[90:91], v124 offset:50176
    ds_read_b64_tr_b16 a[120:121], v125 offset:49152
    ds_read_b64_tr_b16 a[122:123], v125 offset:50176
    ds_read_b64_tr_b16 a[92:93], v124 offset:57344
    ds_read_b64_tr_b16 a[94:95], v124 offset:58368
    ds_read_b64_tr_b16 a[124:125], v125 offset:57344
    ds_read_b64_tr_b16 a[126:127], v125 offset:58368
    s_waitcnt lgkmcnt(0)
    s_branch L_pv1
L_gchk_f:
    s_sub_u32 s55, s55, 1
    s_cbranch_scc1 L_end
    s_branch L_gchk
L_pbar:
    s_barrier
L_pv:
    ds_read_b128 v[110:113], v6
    ds_read_b128 v[114:117], v6 offset:16
    ds_read_b128 v[82:85], v118 offset:0
    ds_read_b128 v[86:89], v118 offset:64
    ds_read_b128 v[90:93], v119 offset:0
    ds_read_b128 v[94:97], v119 offset:64
    ds_read_b128 v[98:101], v120 offset:0
    s_waitcnt lgkmcnt(4)
    v_mfma_f32_16x16x32_bf16 v[102:105], v[82:85], a[64:67], 0
    v_max3_f32 v122, v110, v112, v114
    v_mfma_f32_16x16x32_bf16 v[106:109], v[82:85], a[96:99], 0
    v_max_f32 v122, v122, v116
    ds_read_b128 v[82:85], v120 offset:64
    s_waitcnt lgkmcnt(4)
    v_mfma_f32_16x16x32_bf16 v[102:105], v[86:89], a[68:71], v[102:105]
    v_sub_f32 v110, v110, v122
    v_mfma_f32_16x16x32_bf16 v[106:109], v[86:89], a[100:103], v[106:109]
    v_sub_f32 v112, v112, v122
    ds_read_b128 v[86:89], v121 offset:0
    s_waitcnt lgkmcnt(4)
    v_mfma_f32_16x16x32_bf16 v[102:105], v[90:93], a[72:75], v[102:105]
    v_sub_f32 v114, v114, v122
    v_mfma_f32_16x16x32_bf16 v[106:109], v[90:93], a[104:107], v[106:109]
    v_sub_f32 v116, v116, v122
    ds_read_b128 v[90:93], v121 offset:64
    s_waitcnt lgkmcnt(4)
    v_mfma_f32_16x16x32_bf16 v[102:105], v[94:97], a[76:79], v[102:105]
    v_exp_f32 v110, v110
    v_mfma_f32_16x16x32_bf16 v[106:109], v[94:97], a[108:111], v[106:109]
    v_exp_f32 v112, v112
    s_waitcnt lgkmcnt(3)
    v_mfma_f32_16x16x32_bf16 v[102:105], v[98:101], a[80:83], v[102:105]
    v_exp_f32 v114, v114
    v_mfma_f32_16x16x32_bf16 v[106:109], v[98:101], a[112:115], v[106:109]
    v_exp_f32 v116, v116
    s_waitcnt lgkmcnt(2)
    v_mfma_f32_16x16x32_bf16 v[102:105], v[82:85], a[84:87], v[102:105]
    v_mul_f32 v123, v110, v111
    v_mfma_f32_16x16x32_bf16 v[106:109], v[82:85], a[116:119], v[106:109]
    v_fmac_f32 v123, v112, v113
    s_cmp_eq_u32 s53, 0
    s_cbranch_scc1 L_pv0
L_pv1:
    s_waitcnt lgkmcnt(1)
    v_mfma_f32_16x16x32_bf16 v[102:105], v[86:89], a[88:91], v[102:105]
    v_fmac_f32 v123, v114, v115
    v_mfma_f32_16x16x32_bf16 v[106:109], v[86:89], a[120:123], v[106:109]
    v_fmac_f32 v123, v116, v117
    s_waitcnt lgkmcnt(0)
    v_mfma_f32_16x16x32_bf16 v[102:105], v[90:93], a[92:95], v[102:105]
    v_rcp_f32 v111, v123
    v_mfma_f32_16x16x32_bf16 v[106:109], v[90:93], a[124:127], v[106:109]
    v_log_f32 v123, v123
L_pvt:
    v_lshrrev_b32 v82, 1, v1
    v_add_f32 v123, v123, v122
    s_nop 4
    v_cndmask_b32 v102, v102, v106, s[68:69]
    v_cndmask_b32 v103, v103, v107, s[68:69]
    v_cndmask_b32 v104, v104, v108, s[68:69]
    v_cndmask_b32 v105, v105, v109, s[68:69]
    v_mul_f32 v102, v102, v110
    v_fmac_f32 v102, v103, v112
    v_fmac_f32 v102, v104, v114
    v_fmac_f32 v102, v105, v116
    v_mul_f32 v102, v102, v111
    s_nop 1
    v_mov_b32_dpp v103, v102 quad_perm:[1,0,3,2] row_mask:0xf bank_mask:0xf
    s_mov_b32 exec_lo, 0x55555555
    s_mov_b32 exec_hi, 0x55555555
    v_cvt_pk_bf16_f32 v102, v102, v103
    s_cmp_eq_u32 s54, 0
    s_cbranch_scc1 L_o_slow
    buffer_store_dword v102, v5, s[24:27], s58 offen
    s_cmp_lg_u32 s3, 0
    s_cbranch_scc1 L_nolse_10
    s_mov_b64 exec, 0x10001
    buffer_store_dword v123, v82, s[24:27], s59 offen
L_nolse_10:
    s_mov_b64 exec, -1
L_o_done:
    v_and_b32 v91, 28, v1
    v_add_u32 v95, s74, v2
    s_cmp_eq_u32 s53, 0
    s_cbranch_scc1 L_gb
    s_waitcnt vmcnt(0)
L_gb:
    buffer_load_dword v82, v1, s[24:27], s60 offen offset:0 sc1
    buffer_load_dword v83, v1, s[24:27], s60 offen offset:256 sc1
    buffer_load_dword v84, v1, s[24:27], s60 offen offset:512 sc1
    buffer_load_dword v85, v1, s[24:27], s60 offen offset:768 sc1
    buffer_load_dword v86, v1, s[24:27], s60 offen offset:1024 sc1
    buffer_load_dword v87, v1, s[24:27], s60 offen offset:1280 sc1
    buffer_load_dword v88, v1, s[24:27], s60 offen offset:1536 sc1
    buffer_load_dword v89, v1, s[24:27], s60 offen offset:1792 sc1
    buffer_load_dword v90, v91, s[24:27], s61 offen sc1
    s_waitcnt vmcnt(0)
    v_max3_u32 v93, v82, v83, v84
    v_max3_u32 v93, v93, v85, v86
    v_max3_u32 v93, v93, v87, v88
    v_max3_u32 v93, v93, v89, v90
    v_cmp_eq_u32 vcc, -1, v93
    s_cbranch_vccnz L_gb_f
    v_max_f32_dpp v92, v90, v90 row_ror:4 row_mask:0xf bank_mask:0xf
    v_lshlrev_b32 v98, 16, v82
    v_and_b32 v82, 0xffff0000, v82
    v_max_f32_dpp v92, v92, v92 row_ror:2 row_mask:0xf bank_mask:0xf
    v_lshlrev_b32 v99, 16, v83
    v_and_b32 v83, 0xffff0000, v83
    v_max_f32_dpp v92, v92, v92 row_ror:1 row_mask:0xf bank_mask:0xf
    v_sub_f32 v90, v90, v92
    v_exp_f32 v90, v90
    v_lshlrev_b32 v100, 16, v84
    v_and_b32 v84, 0xffff0000, v84
    v_add_f32_dpp v92, v90, v90 row_ror:4 row_mask:0xf bank_mask:0xf
    v_lshlrev_b32 v101, 16, v85
    v_and_b32 v85, 0xffff0000, v85
    v_add_f32_dpp v92, v92, v92 row_ror:2 row_mask:0xf bank_mask:0xf
    v_lshlrev_b32 v102, 16, v86
    v_and_b32 v86, 0xffff0000, v86
    v_add_f32_dpp v92, v92, v92 row_ror:1 row_mask:0xf bank_mask:0xf
    v_rcp_f32 v92, v92
    v_lshlrev_b32 v103, 16, v87
    v_and_b32 v87, 0xffff0000, v87
    v_mul_f32 v90, v90, v92
    v_lshlrev_b32 v104, 16, v88
    v_and_b32 v88, 0xffff0000, v88
    v_lshlrev_b32 v105, 16, v89
    v_and_b32 v89, 0xffff0000, v89
    v_mul_f32_dpp v93, v90, v98 row_newbcast:0 row_mask:0xf bank_mask:0xf
    v_mul_f32_dpp v94, v90, v82 row_newbcast:0 row_mask:0xf bank_mask:0xf
    v_fmac_f32_dpp v93, v90, v99 row_newbcast:1 row_mask:0xf bank_mask:0xf
    v_fmac_f32_dpp v94, v90, v83 row_newbcast:1 row_mask:0xf bank_mask:0xf
    v_fmac_f32_dpp v93, v90, v100 row_newbcast:2 row_mask:0xf bank_mask:0xf
    v_fmac_f32_dpp v94, v90, v84 row_newbcast:2 row_mask:0xf bank_mask:0xf
    v_fmac_f32_dpp v93, v90, v101 row_newbcast:3 row_mask:0xf bank_mask:0xf
    v_fmac_f32_dpp v94, v90, v85 row_newbcast:3 row_mask:0xf bank_mask:0xf
    v_fmac_f32_dpp v93, v90, v102 row_newbcast:4 row_mask:0xf bank_mask:0xf
    v_fmac_f32_dpp v94, v90, v86 row_newbcast:4 row_mask:0xf bank_mask:0xf
    v_fmac_f32_dpp v93, v90, v103 row_newbcast:5 row_mask:0xf bank_mask:0xf
    v_fmac_f32_dpp v94, v90, v87 row_newbcast:5 row_mask:0xf bank_mask:0xf
    v_fmac_f32_dpp v93, v90, v104 row_newbcast:6 row_mask:0xf bank_mask:0xf
    v_fmac_f32_dpp v94, v90, v88 row_newbcast:6 row_mask:0xf bank_mask:0xf
    v_fmac_f32_dpp v93, v90, v105 row_newbcast:7 row_mask:0xf bank_mask:0xf
    v_fmac_f32_dpp v94, v90, v89 row_newbcast:7 row_mask:0xf bank_mask:0xf
    v_cvt_pk_bf16_f32 v93, v93, v94
    ds_write_b32 v95, v93 offset:2304
    s_waitcnt lgkmcnt(0)
    s_barrier
    s_or_b32 s6, s2, s3
    s_or_b32 s6, s6, s53
    s_cmp_lg_u32 s6, 0
    s_cbranch_scc1 L_cbar
    v_mov_b32 v82, s41
    v_mov_b32 v83, 528384
    s_mov_b64 exec, 1
    buffer_store_dword v82, v83, s[24:27], 0 offen sc1
    s_mov_b64 exec, -1
    s_branch L_cbar
L_o_slow:
    buffer_store_dword v102, v5, s[24:27], s58 offen sc1
    s_cmp_lg_u32 s3, 0
    s_cbranch_scc1 L_nolse_11
    s_mov_b64 exec, 0x10001
    buffer_store_dword v123, v82, s[24:27], s59 offen sc1
L_nolse_11:
    s_mov_b64 exec, -1
    s_waitcnt vmcnt(0)
    s_branch L_o_done
L_gb_f:
    s_sub_u32 s55, s55, 1
    s_cbranch_scc1 L_end
    s_branch L_gb
L_last:
    s_endpgm
.section .rodata,"a"
.p2align 6
.amdhsa_kernel interleave_layers__sliding_block_cached__mixer_token_mlp__decode_kernel
  .amdhsa_next_free_vgpr 256
  .amdhsa_next_free_sgpr 102
  .amdhsa_accum_offset 128
  .amdhsa_group_segment_fixed_size 0
  .amdhsa_kernarg_size 104
  .amdhsa_user_sgpr_count 2
  .amdhsa_user_sgpr_kernarg_segment_ptr 1
  .amdhsa_system_sgpr_workgroup_id_x 1
  .amdhsa_float_denorm_mode_32 3
.end_amdhsa_kernel
```
